```python
import torch

def _softmax(x, axis=-1):
    return torch.softmax(x, dim=axis)
def _gelu(x):
    return torch.nn.functional.gelu(x, approximate="tanh")
def _silu(x):
    return torch.nn.functional.silu(x)
def _sigmoid(x):
    return torch.sigmoid(x)
def _layernorm(x, axis=-1, eps=1e-5):
    m = x.mean(dim=axis, keepdim=True)
    v = x.var(dim=axis, keepdim=True, unbiased=False)
    return (x - m) / torch.sqrt(v + eps)
def _scatter_add(tgt, idx, src, axis=0):
    return tgt.clone().index_add_(axis, idx, src)
def _segment_sum(src, seg, n):
    out = torch.zeros((n,) + src.shape[1:], dtype=src.dtype)
    return out.index_add_(0, seg, src)
def _pad(x, pw):
    flat = tuple(v for pair in reversed(pw) for v in pair)
    return torch.nn.functional.pad(x, flat)

kernel_name = 'standalone__gqa_softmax__sampling'

def setup_inputs():

    _w = (lambda a: (lambda t: t.to(torch.bfloat16) if t.is_floating_point() else t)(torch.as_tensor(a)))
    B, Hq, Hkv, Sq, Sk, D = 16, 32, 8, 16, 4096, 128
    return {
        "q": _w((lambda *s: torch.randn(*s, dtype=torch.bfloat16) * 0.8)(B, Hq, Sq, D)),
        "k": _w((lambda *s: torch.randn(*s, dtype=torch.bfloat16) * 0.8)(B, Hkv, Sk, D)),
        "v": _w((lambda *s: torch.randn(*s, dtype=torch.bfloat16) * 0.05)(B, Hkv, Sk, D)),
    }

def reference(q, k, v):
    B, Hq, Sq, D = q.shape
    Hkv = k.shape[1]
    rep = Hq // Hkv
    k = (lambda x, n, axis: torch.repeat_interleave(x, n, dim=axis))(k, rep, axis=1)
    v = (lambda x, n, axis: torch.repeat_interleave(x, n, dim=axis))(v, rep, axis=1)
    scale = D ** -0.5
    scores = torch.einsum("bhqd,bhkd->bhqk", q, k) * scale
    p = _softmax(scores, axis=-1)
    return torch.einsum("bhqk,bhkd->bhqd", p, v)
```

```asm
; @launch grid=(256,1,1) block=(512,1,1) lds=151616
.amdgcn_target "amdgcn-amd-amdhsa--gfx950"
.text
.globl standalone__gqa_softmax__sampling_kernel
.p2align 12
.p2align 8
.type standalone__gqa_softmax__sampling_kernel,@function
standalone__gqa_softmax__sampling_kernel:
  s_load_dwordx8 s[28:35], s[0:1], 0
  s_load_dwordx4 s[36:39], s[0:1], 32
  s_cmp_ge_u32 s2, 256
  s_cbranch_scc1 L_end
  v_readfirstlane_b32 s20, v0
  s_and_b32 s42, s2, 7
  s_lshr_b32 s43, s2, 4
  s_lshl_b32 s43, s43, 3
  s_or_b32 s40, s42, s43
  s_bfe_u32 s41, s2, 0x10003
  s_lshr_b32 s20, s20, 6
  s_cmp_eq_u32 s20, 0
  s_cbranch_scc1 L_loader
  s_cmp_lt_u32 s20, 5
  s_cbranch_scc1 L_compute
  s_cmp_eq_u32 s20, 6
  s_cbranch_scc1 L_touch0
  s_cmp_eq_u32 s20, 7
  s_cbranch_scc1 L_touch1
  s_branch L_touch2
L_loader:
  s_setprio 3
  v_and_b32 v2, 15, v0
  v_lshrrev_b32 v3, 4, v0
  s_lshl_b32 s43, s41, 15
  s_addk_i32 s43, 4096
  v_lshl_add_u32 v1, v3, 12, s43
  v_xor_b32 v12, v2, v3
  v_lshl_add_u32 v4, v12, 4, v1
  v_xor_b32 v13, 4, v12
  v_lshl_add_u32 v5, v13, 4, v1
  v_add_u32 v5, 15360, v5
  v_xor_b32 v13, 8, v12
  v_lshl_add_u32 v6, v13, 4, v1
  v_add_u32 v6, -1792, v6
  v_xor_b32 v13, 12, v12
  v_lshl_add_u32 v7, v13, 4, v1
  v_add_u32 v7, 13568, v7
  s_mov_b32 s6, 1052672
  s_mov_b32 s7, 0x20000
  s_mov_b32 m0, 0
  s_mov_b32 s22, 0
  s_mov_b32 s23, s22
  s_lshl_b32 s42, s40, 20
  s_sub_u32 s42, s42, 4096
  s_subb_u32 s44, 0, 0
  s_waitcnt lgkmcnt(0)
  s_add_u32 s4, s30, s42
  s_addc_u32 s5, s31, s44
  s_nop 0
  buffer_load_dwordx4 v4, s[4:7], s22 offen offset:0 nt lds
  buffer_load_dwordx4 v5, s[4:7], s22 offen offset:1024 nt lds
  buffer_load_dwordx4 v6, s[4:7], s22 offen offset:2048 nt lds
  buffer_load_dwordx4 v7, s[4:7], s22 offen offset:3072 nt lds
  s_addk_i32 s22, 512
  s_addk_i32 m0, 4096
  s_nop 0
  buffer_load_dwordx4 v4, s[4:7], s22 offen offset:0 nt lds
  buffer_load_dwordx4 v5, s[4:7], s22 offen offset:1024 nt lds
  buffer_load_dwordx4 v6, s[4:7], s22 offen offset:2048 nt lds
  buffer_load_dwordx4 v7, s[4:7], s22 offen offset:3072 nt lds
  s_addk_i32 s22, 512
  s_addk_i32 m0, 4096
  s_nop 0
  buffer_load_dwordx4 v4, s[4:7], s22 offen offset:0 nt lds
  buffer_load_dwordx4 v5, s[4:7], s22 offen offset:1024 nt lds
  buffer_load_dwordx4 v6, s[4:7], s22 offen offset:2048 nt lds
  buffer_load_dwordx4 v7, s[4:7], s22 offen offset:3072 nt lds
  s_addk_i32 s22, 512
  s_addk_i32 m0, 4096
  s_nop 0
  buffer_load_dwordx4 v4, s[4:7], s22 offen offset:0 nt lds
  buffer_load_dwordx4 v5, s[4:7], s22 offen offset:1024 nt lds
  buffer_load_dwordx4 v6, s[4:7], s22 offen offset:2048 nt lds
  buffer_load_dwordx4 v7, s[4:7], s22 offen offset:3072 nt lds
  s_addk_i32 s22, 512
  s_addk_i32 m0, 4096
  s_nop 0
  buffer_load_dwordx4 v4, s[4:7], s22 offen offset:0 nt lds
  buffer_load_dwordx4 v5, s[4:7], s22 offen offset:1024 nt lds
  buffer_load_dwordx4 v6, s[4:7], s22 offen offset:2048 nt lds
  buffer_load_dwordx4 v7, s[4:7], s22 offen offset:3072 nt lds
  s_addk_i32 s22, 512
  s_addk_i32 m0, 4096
  s_nop 0
  buffer_load_dwordx4 v4, s[4:7], s22 offen offset:0 nt lds
  s_add_u32 s8, s32, s42
  s_addc_u32 s9, s33, s44
  v_lshlrev_b32 v12, 1, v3
  v_xor_b32 v12, v2, v12
  v_lshl_add_u32 v8, v12, 4, v1
  v_xor_b32 v13, 8, v12
  v_lshl_add_u32 v9, v13, 4, v1
  v_add_u32 v10, -1792, v8
  v_add_u32 v11, 13568, v9
  v_add_u32 v9, 15360, v9
  v_mov_b32 v12, 151556
  s_mov_b32 s21, 1
  s_mov_b32 s12, s34
  s_mov_b32 s13, s35
  s_mov_b32 s14, 0x200000
  s_mov_b32 s15, 0x20000
  s_lshl_b32 s66, s40, 14
  s_lshl_b32 s45, s41, 7
  s_or_b32 s66, s66, s45
  v_lshlrev_b32 v14, 8, v0
  v_and_b32 v18, 7, v0
  v_lshlrev_b32 v19, 1, v3
  v_xor_b32 v18, v18, v19
  v_lshl_add_u32 v18, v18, 4, s43
  v_bfe_u32 v19, v0, 3, 1
  v_lshl_add_u32 v18, v19, 12, v18
  v_bfe_u32 v19, v0, 4, 1
  v_lshl_add_u32 v18, v19, 13, v18
  v_lshrrev_b32 v19, 5, v0
  v_lshl_add_u32 v18, v19, 14, v18
  v_add_u32 v28, s45, v18
  v_add_u32 v29, -768, v28
  v_add_u32 v30, -1536, v28
  v_add_u32 v31, -2304, v28
  v_xor_b32 v24, 128, v28
  v_xor_b32 v25, 128, v29
  v_xor_b32 v26, 128, v30
  v_xor_b32 v27, 128, v31
  s_waitcnt vmcnt(20)
  buffer_load_dwordx4 v5, s[4:7], s22 offen offset:1024 nt lds
  s_waitcnt vmcnt(20)
  buffer_load_dwordx4 v6, s[4:7], s22 offen offset:2048 nt lds
  s_waitcnt vmcnt(20)
  buffer_load_dwordx4 v7, s[4:7], s22 offen offset:3072 nt lds
  s_addk_i32 s22, 512
  s_addk_i32 m0, 4096
  s_waitcnt vmcnt(20)
  buffer_load_dwordx4 v4, s[4:7], s22 offen offset:0 nt lds
  s_waitcnt vmcnt(20)
  buffer_load_dwordx4 v5, s[4:7], s22 offen offset:1024 nt lds
  s_waitcnt vmcnt(20)
  buffer_load_dwordx4 v6, s[4:7], s22 offen offset:2048 nt lds
  s_waitcnt vmcnt(20)
  buffer_load_dwordx4 v7, s[4:7], s22 offen offset:3072 nt lds
  s_addk_i32 s22, 512
  s_addk_i32 m0, 4096
  s_waitcnt vmcnt(20)
  buffer_load_dwordx4 v4, s[4:7], s22 offen offset:0 nt lds
  s_waitcnt vmcnt(20)
  buffer_load_dwordx4 v5, s[4:7], s22 offen offset:1024 nt lds
  s_waitcnt vmcnt(20)
  buffer_load_dwordx4 v6, s[4:7], s22 offen offset:2048 nt lds
  s_waitcnt vmcnt(20)
  buffer_load_dwordx4 v7, s[4:7], s22 offen offset:3072 nt lds
  s_add_u32 s22, s22, 61952
  s_addk_i32 m0, 4096
L_ld_v4:
  s_waitcnt vmcnt(20)
  buffer_load_dwordx4 v4, s[4:7], s22 offen offset:0 nt lds
  s_waitcnt vmcnt(20)
  buffer_load_dwordx4 v5, s[4:7], s22 offen offset:1024 nt lds
  s_waitcnt vmcnt(20)
  buffer_load_dwordx4 v6, s[4:7], s22 offen offset:2048 nt lds
  s_waitcnt vmcnt(20)
  buffer_load_dwordx4 v7, s[4:7], s22 offen offset:3072 nt lds
  s_addk_i32 s22, 512
  s_addk_i32 m0, 4096
  s_waitcnt vmcnt(20)
  buffer_load_dwordx4 v4, s[4:7], s22 offen offset:0 nt lds
  s_waitcnt vmcnt(20)
  buffer_load_dwordx4 v5, s[4:7], s22 offen offset:1024 nt lds
  s_waitcnt vmcnt(20)
  buffer_load_dwordx4 v6, s[4:7], s22 offen offset:2048 nt lds
  s_waitcnt vmcnt(20)
  buffer_load_dwordx4 v7, s[4:7], s22 offen offset:3072 nt lds
  s_addk_i32 s22, 512
  s_addk_i32 m0, 4096
  s_waitcnt vmcnt(20)
  buffer_load_dwordx4 v4, s[4:7], s22 offen offset:0 nt lds
  s_waitcnt vmcnt(20)
  buffer_load_dwordx4 v5, s[4:7], s22 offen offset:1024 nt lds
  s_waitcnt vmcnt(20)
  buffer_load_dwordx4 v6, s[4:7], s22 offen offset:2048 nt lds
  s_waitcnt vmcnt(20)
  buffer_load_dwordx4 v7, s[4:7], s22 offen offset:3072 nt lds
  s_addk_i32 s22, 512
  s_addk_i32 m0, 4096
  s_waitcnt vmcnt(20)
  buffer_load_dwordx4 v4, s[4:7], s22 offen offset:0 nt lds
  s_waitcnt vmcnt(20)
  buffer_load_dwordx4 v5, s[4:7], s22 offen offset:1024 nt lds
  s_waitcnt vmcnt(20)
  buffer_load_dwordx4 v6, s[4:7], s22 offen offset:2048 nt lds
  s_waitcnt vmcnt(20)
  buffer_load_dwordx4 v7, s[4:7], s22 offen offset:3072 nt lds
  s_addk_i32 s22, 512
  s_addk_i32 m0, 4096
  s_waitcnt vmcnt(20)
  buffer_load_dwordx4 v4, s[4:7], s22 offen offset:0 nt lds
  s_waitcnt vmcnt(20)
  buffer_load_dwordx4 v5, s[4:7], s22 offen offset:1024 nt lds
  s_waitcnt vmcnt(20)
  buffer_load_dwordx4 v6, s[4:7], s22 offen offset:2048 nt lds
  s_waitcnt vmcnt(20)
  buffer_load_dwordx4 v7, s[4:7], s22 offen offset:3072 nt lds
  s_addk_i32 s22, 512
  s_addk_i32 m0, 4096
  s_waitcnt vmcnt(20)
  buffer_load_dwordx4 v4, s[4:7], s22 offen offset:0 nt lds
  s_barrier
  s_waitcnt vmcnt(20)
  buffer_load_dwordx4 v5, s[4:7], s22 offen offset:1024 nt lds
  s_waitcnt vmcnt(20)
  buffer_load_dwordx4 v6, s[4:7], s22 offen offset:2048 nt lds
  s_waitcnt vmcnt(20)
  buffer_load_dwordx4 v7, s[4:7], s22 offen offset:3072 nt lds
  s_addk_i32 s22, 512
  s_addk_i32 m0, 4096
  s_waitcnt vmcnt(20)
  buffer_load_dwordx4 v4, s[4:7], s22 offen offset:0 nt lds
  s_waitcnt vmcnt(20)
  buffer_load_dwordx4 v5, s[4:7], s22 offen offset:1024 nt lds
  s_waitcnt vmcnt(20)
  buffer_load_dwordx4 v6, s[4:7], s22 offen offset:2048 nt lds
  s_waitcnt vmcnt(20)
  buffer_load_dwordx4 v7, s[4:7], s22 offen offset:3072 nt lds
  s_addk_i32 s22, 512
  s_addk_i32 m0, 4096
  ds_read_b32 v13, v12
  s_waitcnt vmcnt(20)
  buffer_load_dwordx4 v4, s[4:7], s22 offen offset:0 nt lds
  s_waitcnt vmcnt(20)
  buffer_load_dwordx4 v5, s[4:7], s22 offen offset:1024 nt lds
  s_waitcnt vmcnt(20)
  buffer_load_dwordx4 v6, s[4:7], s22 offen offset:2048 nt lds
  s_waitcnt vmcnt(20)
  buffer_load_dwordx4 v7, s[4:7], s22 offen offset:3072 nt lds
  s_add_u32 s22, s22, 61952
  s_addk_i32 m0, 4096
  s_cmp_ge_u32 m0, 98304
  s_cselect_b32 m0, 0, m0
  s_add_u32 s21, s21, 1
  s_and_b32 s42, s21, 15
  s_cbranch_scc0 L_ld_swap
  s_cmp_eq_u32 s21, 30
  s_cbranch_scc1 L_ld_tail
  s_waitcnt lgkmcnt(0)
  v_readfirstlane_b32 s42, v13
  s_cmp_eq_u32 s42, 4
  s_cbranch_scc1 L_ld_v4
  s_branch L_ld_dispatch
L_ld_swap:
  s_mov_b64 s[46:47], s[4:5]
  s_mov_b64 s[4:5], s[8:9]
  s_mov_b64 s[8:9], s[46:47]
  s_mov_b32 s42, s22
  s_mov_b32 s22, s23
  s_mov_b32 s23, s42
  v_swap_b32 v4, v8
  v_swap_b32 v5, v9
  v_swap_b32 v6, v10
  v_swap_b32 v7, v11
  s_waitcnt lgkmcnt(0)
  v_readfirstlane_b32 s42, v13
L_ld_dispatch:
  s_cmp_ge_u32 s42, 4
  s_cbranch_scc1 L_dsp_4_8
  s_cmp_ge_u32 s42, 2
  s_cbranch_scc1 L_dsp_2_3
  s_cmp_ge_u32 s42, 1
  s_cbranch_scc1 L_ld_v1
  s_branch L_ld_v0
L_dsp_2_3:
  s_cmp_ge_u32 s42, 3
  s_cbranch_scc1 L_ld_v3
  s_branch L_ld_v2
L_dsp_4_8:
  s_cmp_ge_u32 s42, 6
  s_cbranch_scc1 L_dsp_6_8
  s_cmp_ge_u32 s42, 5
  s_cbranch_scc1 L_ld_v5
  s_branch L_ld_v4
L_dsp_6_8:
  s_cmp_ge_u32 s42, 7
  s_cbranch_scc1 L_dsp_7_8
  s_branch L_ld_v6
L_dsp_7_8:
  s_cmp_ge_u32 s42, 8
  s_cbranch_scc1 L_ld_v8
  s_branch L_ld_v7
L_ld_v3:
  s_waitcnt vmcnt(19)
  buffer_load_dwordx4 v4, s[4:7], s22 offen offset:0 nt lds
  s_waitcnt vmcnt(19)
  buffer_load_dwordx4 v5, s[4:7], s22 offen offset:1024 nt lds
  s_waitcnt vmcnt(19)
  buffer_load_dwordx4 v6, s[4:7], s22 offen offset:2048 nt lds
  s_waitcnt vmcnt(19)
  buffer_load_dwordx4 v7, s[4:7], s22 offen offset:3072 nt lds
  s_addk_i32 s22, 512
  s_addk_i32 m0, 4096
  s_waitcnt vmcnt(19)
  buffer_load_dwordx4 v4, s[4:7], s22 offen offset:0 nt lds
  s_waitcnt vmcnt(19)
  buffer_load_dwordx4 v5, s[4:7], s22 offen offset:1024 nt lds
  s_waitcnt vmcnt(19)
  buffer_load_dwordx4 v6, s[4:7], s22 offen offset:2048 nt lds
  s_waitcnt vmcnt(19)
  buffer_load_dwordx4 v7, s[4:7], s22 offen offset:3072 nt lds
  s_addk_i32 s22, 512
  s_addk_i32 m0, 4096
  s_waitcnt vmcnt(19)
  buffer_load_dwordx4 v4, s[4:7], s22 offen offset:0 nt lds
  s_waitcnt vmcnt(19)
  buffer_load_dwordx4 v5, s[4:7], s22 offen offset:1024 nt lds
  s_waitcnt vmcnt(19)
  buffer_load_dwordx4 v6, s[4:7], s22 offen offset:2048 nt lds
  s_waitcnt vmcnt(19)
  buffer_load_dwordx4 v7, s[4:7], s22 offen offset:3072 nt lds
  s_addk_i32 s22, 512
  s_addk_i32 m0, 4096
  s_waitcnt vmcnt(19)
  buffer_load_dwordx4 v4, s[4:7], s22 offen offset:0 nt lds
  s_waitcnt vmcnt(19)
  buffer_load_dwordx4 v5, s[4:7], s22 offen offset:1024 nt lds
  s_waitcnt vmcnt(19)
  buffer_load_dwordx4 v6, s[4:7], s22 offen offset:2048 nt lds
  s_waitcnt vmcnt(19)
  buffer_load_dwordx4 v7, s[4:7], s22 offen offset:3072 nt lds
  s_addk_i32 s22, 512
  s_addk_i32 m0, 4096
  s_waitcnt vmcnt(19)
  buffer_load_dwordx4 v4, s[4:7], s22 offen offset:0 nt lds
  s_waitcnt vmcnt(19)
  buffer_load_dwordx4 v5, s[4:7], s22 offen offset:1024 nt lds
  s_waitcnt vmcnt(19)
  buffer_load_dwordx4 v6, s[4:7], s22 offen offset:2048 nt lds
  s_waitcnt vmcnt(19)
  buffer_load_dwordx4 v7, s[4:7], s22 offen offset:3072 nt lds
  s_barrier
  s_addk_i32 s22, 512
  s_addk_i32 m0, 4096
  s_waitcnt vmcnt(19)
  buffer_load_dwordx4 v4, s[4:7], s22 offen offset:0 nt lds
  s_waitcnt vmcnt(19)
  buffer_load_dwordx4 v5, s[4:7], s22 offen offset:1024 nt lds
  s_waitcnt vmcnt(19)
  buffer_load_dwordx4 v6, s[4:7], s22 offen offset:2048 nt lds
  s_waitcnt vmcnt(19)
  buffer_load_dwordx4 v7, s[4:7], s22 offen offset:3072 nt lds
  s_addk_i32 s22, 512
  s_addk_i32 m0, 4096
  s_waitcnt vmcnt(19)
  buffer_load_dwordx4 v4, s[4:7], s22 offen offset:0 nt lds
  s_waitcnt vmcnt(19)
  buffer_load_dwordx4 v5, s[4:7], s22 offen offset:1024 nt lds
  s_waitcnt vmcnt(19)
  buffer_load_dwordx4 v6, s[4:7], s22 offen offset:2048 nt lds
  s_waitcnt vmcnt(19)
  buffer_load_dwordx4 v7, s[4:7], s22 offen offset:3072 nt lds
  s_addk_i32 s22, 512
  s_addk_i32 m0, 4096
  ds_read_b32 v13, v12
  s_waitcnt vmcnt(19)
  buffer_load_dwordx4 v4, s[4:7], s22 offen offset:0 nt lds
  s_waitcnt vmcnt(19)
  buffer_load_dwordx4 v5, s[4:7], s22 offen offset:1024 nt lds
  s_waitcnt vmcnt(19)
  buffer_load_dwordx4 v6, s[4:7], s22 offen offset:2048 nt lds
  s_waitcnt vmcnt(19)
  buffer_load_dwordx4 v7, s[4:7], s22 offen offset:3072 nt lds
  s_add_u32 s22, s22, 61952
  s_addk_i32 m0, 4096
  s_cmp_ge_u32 m0, 98304
  s_cselect_b32 m0, 0, m0
  s_add_u32 s21, s21, 1
  s_and_b32 s42, s21, 15
  s_cbranch_scc0 L_ld_swap
  s_cmp_eq_u32 s21, 30
  s_cbranch_scc1 L_ld_tail
  s_waitcnt lgkmcnt(0)
  v_readfirstlane_b32 s42, v13
  s_cmp_eq_u32 s42, 3
  s_cbranch_scc1 L_ld_v3
  s_branch L_ld_dispatch
L_touch0:
  s_branch L_touch3
L_ld_v5:
  s_waitcnt vmcnt(21)
  buffer_load_dwordx4 v4, s[4:7], s22 offen offset:0 nt lds
  s_waitcnt vmcnt(21)
  buffer_load_dwordx4 v5, s[4:7], s22 offen offset:1024 nt lds
  s_waitcnt vmcnt(21)
  buffer_load_dwordx4 v6, s[4:7], s22 offen offset:2048 nt lds
  s_waitcnt vmcnt(21)
  buffer_load_dwordx4 v7, s[4:7], s22 offen offset:3072 nt lds
  s_addk_i32 s22, 512
  s_addk_i32 m0, 4096
  s_waitcnt vmcnt(21)
  buffer_load_dwordx4 v4, s[4:7], s22 offen offset:0 nt lds
  s_waitcnt vmcnt(21)
  buffer_load_dwordx4 v5, s[4:7], s22 offen offset:1024 nt lds
  s_waitcnt vmcnt(21)
  buffer_load_dwordx4 v6, s[4:7], s22 offen offset:2048 nt lds
  s_waitcnt vmcnt(21)
  buffer_load_dwordx4 v7, s[4:7], s22 offen offset:3072 nt lds
  s_addk_i32 s22, 512
  s_addk_i32 m0, 4096
  s_waitcnt vmcnt(21)
  buffer_load_dwordx4 v4, s[4:7], s22 offen offset:0 nt lds
  s_waitcnt vmcnt(21)
  buffer_load_dwordx4 v5, s[4:7], s22 offen offset:1024 nt lds
  s_waitcnt vmcnt(21)
  buffer_load_dwordx4 v6, s[4:7], s22 offen offset:2048 nt lds
  s_waitcnt vmcnt(21)
  buffer_load_dwordx4 v7, s[4:7], s22 offen offset:3072 nt lds
  s_addk_i32 s22, 512
  s_addk_i32 m0, 4096
  s_waitcnt vmcnt(21)
  buffer_load_dwordx4 v4, s[4:7], s22 offen offset:0 nt lds
  s_waitcnt vmcnt(21)
  buffer_load_dwordx4 v5, s[4:7], s22 offen offset:1024 nt lds
  s_waitcnt vmcnt(21)
  buffer_load_dwordx4 v6, s[4:7], s22 offen offset:2048 nt lds
  s_waitcnt vmcnt(21)
  buffer_load_dwordx4 v7, s[4:7], s22 offen offset:3072 nt lds
  s_addk_i32 s22, 512
  s_addk_i32 m0, 4096
  s_waitcnt vmcnt(21)
  buffer_load_dwordx4 v4, s[4:7], s22 offen offset:0 nt lds
  s_waitcnt vmcnt(21)
  buffer_load_dwordx4 v5, s[4:7], s22 offen offset:1024 nt lds
  s_waitcnt vmcnt(21)
  buffer_load_dwordx4 v6, s[4:7], s22 offen offset:2048 nt lds
  s_waitcnt vmcnt(21)
  buffer_load_dwordx4 v7, s[4:7], s22 offen offset:3072 nt lds
  s_addk_i32 s22, 512
  s_addk_i32 m0, 4096
  s_waitcnt vmcnt(21)
  buffer_load_dwordx4 v4, s[4:7], s22 offen offset:0 nt lds
  s_waitcnt vmcnt(21)
  buffer_load_dwordx4 v5, s[4:7], s22 offen offset:1024 nt lds
  s_barrier
  s_waitcnt vmcnt(21)
  buffer_load_dwordx4 v6, s[4:7], s22 offen offset:2048 nt lds
  s_waitcnt vmcnt(21)
  buffer_load_dwordx4 v7, s[4:7], s22 offen offset:3072 nt lds
  s_addk_i32 s22, 512
  s_addk_i32 m0, 4096
  s_waitcnt vmcnt(21)
  buffer_load_dwordx4 v4, s[4:7], s22 offen offset:0 nt lds
  s_waitcnt vmcnt(21)
  buffer_load_dwordx4 v5, s[4:7], s22 offen offset:1024 nt lds
  s_waitcnt vmcnt(21)
  buffer_load_dwordx4 v6, s[4:7], s22 offen offset:2048 nt lds
  s_waitcnt vmcnt(21)
  buffer_load_dwordx4 v7, s[4:7], s22 offen offset:3072 nt lds
  s_addk_i32 s22, 512
  s_addk_i32 m0, 4096
  ds_read_b32 v13, v12
  s_waitcnt vmcnt(21)
  buffer_load_dwordx4 v4, s[4:7], s22 offen offset:0 nt lds
  s_waitcnt vmcnt(21)
  buffer_load_dwordx4 v5, s[4:7], s22 offen offset:1024 nt lds
  s_waitcnt vmcnt(21)
  buffer_load_dwordx4 v6, s[4:7], s22 offen offset:2048 nt lds
  s_waitcnt vmcnt(21)
  buffer_load_dwordx4 v7, s[4:7], s22 offen offset:3072 nt lds
  s_add_u32 s22, s22, 61952
  s_addk_i32 m0, 4096
  s_cmp_ge_u32 m0, 98304
  s_cselect_b32 m0, 0, m0
  s_add_u32 s21, s21, 1
  s_and_b32 s42, s21, 15
  s_cbranch_scc0 L_ld_swap
  s_cmp_eq_u32 s21, 30
  s_cbranch_scc1 L_ld_tail
  s_waitcnt lgkmcnt(0)
  v_readfirstlane_b32 s42, v13
  s_cmp_eq_u32 s42, 5
  s_cbranch_scc1 L_ld_v5
  s_branch L_ld_dispatch
L_hook:
  s_cmp_ge_u32 s21, 17
  s_cbranch_scc1 L_hook4
  s_mov_b64 exec, 1
  s_cmp_eq_u32 s21, 5
  s_cbranch_scc0 L_hook2
  s_cmp_eq_u32 s41, 0
  s_cbranch_scc1 L_hook_noswap
  v_swap_b32 v250, v251
L_hook_noswap:
  v_add_u32 v250, s77, v250
  buffer_store_dword v250, v244, s[16:19], s82 offen offset:264
  s_mov_b32 s64, 13
  s_branch L_hook_out
L_hook2:
  s_cmp_eq_u32 s21, 13
  s_cbranch_scc0 L_hook3
  buffer_load_dword v243, v244, s[16:19], s83 offen offset:264 sc1
  s_mov_b32 s64, 14
  s_branch L_hook_out
L_hook3:
  v_sub_u32 v243, v243, v251
  v_cmp_eq_u32 vcc, s77, v243
  v_mov_b32 v243, 0
  s_cbranch_vccnz L_hook_mode
  s_lshl_b32 s42, 1, s70
  v_mov_b32 v243, s42
  buffer_atomic_or v243, v244, s[60:63], s76 offen sc0 sc1
  s_waitcnt vmcnt(0)
  v_bfe_u32 v243, v243, s70, 1
  v_add_u32 v243, 1, v243
L_hook_mode:
  v_mov_b32 v230, 151552
  ds_write_b32 v230, v243
  s_mov_b32 s64, 17
  s_waitcnt lgkmcnt(0)
L_hook_out:
  s_mov_b64 exec, -1
  s_branch L_hook_ret
L_hook4:
  s_cmp_eq_u32 s21, 17
  s_cbranch_scc0 L_hook5
  v_mov_b32 v230, 151552
  ds_read_b32 v243, v230
  s_cmp_eq_u32 s41, 0
  s_cbranch_scc1 L_hook_noswap2
  v_swap_b32 v248, v249
L_hook_noswap2:
  v_add_u32 v248, 1, v248
  v_mov_b32 v241, v249
  v_mov_b64 v[234:235], -1
  v_mov_b64 v[236:237], -1
  v_mov_b32 v230, v229
  v_mov_b32 v231, v229
  s_nop 1
  v_permlane32_swap_b32 v230, v231
  v_add_f32 v230, v230, v231
  v_mov_b32 v231, v230
  s_nop 1
  v_permlane16_swap_b32 v230, v231
  v_add_f32 v229, v230, v231
  s_waitcnt lgkmcnt(0)
  v_readfirstlane_b32 s68, v243
  s_cmp_lg_u32 s68, 0
  s_cbranch_scc1 L_hook_ret
  buffer_store_dwordx4 v[234:237], v252, s[12:15], s67 offen
  buffer_store_dwordx4 v[234:237], v252, s[12:15], s67 offen offset:2048
  buffer_store_dwordx2 v[228:229], v240, s[16:19], s80 offen
  s_mov_b32 s64, 18
  s_branch L_hook_ret
L_hook5:
  s_cmp_eq_u32 s21, 18
  s_cbranch_scc0 L_hook6
  buffer_store_dword v248, v244, s[16:19], s82 offen offset:256
  s_mov_b32 s64, 20
  s_branch L_hook_ret
L_hook6:
  s_cmp_eq_u32 s21, 20
  s_cbranch_scc0 L_hook7
  buffer_load_dword v241, v244, s[16:19], s83 offen offset:256 sc1
  s_mov_b32 s64, 21
  s_branch L_hook_ret
L_hook7:
  buffer_load_dwordx2 v[4:5], v240, s[16:19], s81 offen sc1
  s_branch L_hook_ret
.p2align 12
L_touch1:
  s_branch L_touch4
L_ld_v2:
  s_waitcnt vmcnt(18)
  buffer_load_dwordx4 v4, s[4:7], s22 offen offset:0 nt lds
  s_waitcnt vmcnt(18)
  buffer_load_dwordx4 v5, s[4:7], s22 offen offset:1024 nt lds
  s_waitcnt vmcnt(18)
  buffer_load_dwordx4 v6, s[4:7], s22 offen offset:2048 nt lds
  s_waitcnt vmcnt(18)
  buffer_load_dwordx4 v7, s[4:7], s22 offen offset:3072 nt lds
  s_addk_i32 s22, 512
  s_addk_i32 m0, 4096
  s_waitcnt vmcnt(18)
  buffer_load_dwordx4 v4, s[4:7], s22 offen offset:0 nt lds
  s_waitcnt vmcnt(18)
  buffer_load_dwordx4 v5, s[4:7], s22 offen offset:1024 nt lds
  s_waitcnt vmcnt(18)
  buffer_load_dwordx4 v6, s[4:7], s22 offen offset:2048 nt lds
  s_waitcnt vmcnt(18)
  buffer_load_dwordx4 v7, s[4:7], s22 offen offset:3072 nt lds
  s_addk_i32 s22, 512
  s_addk_i32 m0, 4096
  s_waitcnt vmcnt(18)
  buffer_load_dwordx4 v4, s[4:7], s22 offen offset:0 nt lds
  s_waitcnt vmcnt(18)
  buffer_load_dwordx4 v5, s[4:7], s22 offen offset:1024 nt lds
  s_waitcnt vmcnt(18)
  buffer_load_dwordx4 v6, s[4:7], s22 offen offset:2048 nt lds
  s_waitcnt vmcnt(18)
  buffer_load_dwordx4 v7, s[4:7], s22 offen offset:3072 nt lds
  s_addk_i32 s22, 512
  s_addk_i32 m0, 4096
  s_waitcnt vmcnt(18)
  buffer_load_dwordx4 v4, s[4:7], s22 offen offset:0 nt lds
  s_waitcnt vmcnt(18)
  buffer_load_dwordx4 v5, s[4:7], s22 offen offset:1024 nt lds
  s_waitcnt vmcnt(18)
  buffer_load_dwordx4 v6, s[4:7], s22 offen offset:2048 nt lds
  s_waitcnt vmcnt(18)
  buffer_load_dwordx4 v7, s[4:7], s22 offen offset:3072 nt lds
  s_addk_i32 s22, 512
  s_addk_i32 m0, 4096
  s_waitcnt vmcnt(18)
  buffer_load_dwordx4 v4, s[4:7], s22 offen offset:0 nt lds
  s_waitcnt vmcnt(18)
  buffer_load_dwordx4 v5, s[4:7], s22 offen offset:1024 nt lds
  s_waitcnt vmcnt(18)
  buffer_load_dwordx4 v6, s[4:7], s22 offen offset:2048 nt lds
  s_barrier
  s_waitcnt vmcnt(18)
  buffer_load_dwordx4 v7, s[4:7], s22 offen offset:3072 nt lds
  s_addk_i32 s22, 512
  s_addk_i32 m0, 4096
  s_waitcnt vmcnt(18)
  buffer_load_dwordx4 v4, s[4:7], s22 offen offset:0 nt lds
  s_waitcnt vmcnt(18)
  buffer_load_dwordx4 v5, s[4:7], s22 offen offset:1024 nt lds
  s_waitcnt vmcnt(18)
  buffer_load_dwordx4 v6, s[4:7], s22 offen offset:2048 nt lds
  s_waitcnt vmcnt(18)
  buffer_load_dwordx4 v7, s[4:7], s22 offen offset:3072 nt lds
  s_addk_i32 s22, 512
  s_addk_i32 m0, 4096
  s_waitcnt vmcnt(18)
  buffer_load_dwordx4 v4, s[4:7], s22 offen offset:0 nt lds
  s_waitcnt vmcnt(18)
  buffer_load_dwordx4 v5, s[4:7], s22 offen offset:1024 nt lds
  s_waitcnt vmcnt(18)
  buffer_load_dwordx4 v6, s[4:7], s22 offen offset:2048 nt lds
  s_waitcnt vmcnt(18)
  buffer_load_dwordx4 v7, s[4:7], s22 offen offset:3072 nt lds
  s_addk_i32 s22, 512
  s_addk_i32 m0, 4096
  ds_read_b32 v13, v12
  s_waitcnt vmcnt(18)
  buffer_load_dwordx4 v4, s[4:7], s22 offen offset:0 nt lds
  s_waitcnt vmcnt(18)
  buffer_load_dwordx4 v5, s[4:7], s22 offen offset:1024 nt lds
  s_waitcnt vmcnt(18)
  buffer_load_dwordx4 v6, s[4:7], s22 offen offset:2048 nt lds
  s_waitcnt vmcnt(18)
  buffer_load_dwordx4 v7, s[4:7], s22 offen offset:3072 nt lds
  s_add_u32 s22, s22, 61952
  s_addk_i32 m0, 4096
  s_cmp_ge_u32 m0, 98304
  s_cselect_b32 m0, 0, m0
  s_add_u32 s21, s21, 1
  s_and_b32 s42, s21, 15
  s_cbranch_scc0 L_ld_swap
  s_cmp_eq_u32 s21, 30
  s_cbranch_scc1 L_ld_tail
  s_waitcnt lgkmcnt(0)
  v_readfirstlane_b32 s42, v13
  s_cmp_eq_u32 s42, 2
  s_cbranch_scc1 L_ld_v2
  s_branch L_ld_dispatch
L_ld_v6:
  s_waitcnt vmcnt(22)
  buffer_load_dwordx4 v4, s[4:7], s22 offen offset:0 nt lds
  s_waitcnt vmcnt(22)
  buffer_load_dwordx4 v5, s[4:7], s22 offen offset:1024 nt lds
  s_waitcnt vmcnt(22)
  buffer_load_dwordx4 v6, s[4:7], s22 offen offset:2048 nt lds
  s_waitcnt vmcnt(22)
  buffer_load_dwordx4 v7, s[4:7], s22 offen offset:3072 nt lds
  s_addk_i32 s22, 512
  s_addk_i32 m0, 4096
  s_waitcnt vmcnt(22)
  buffer_load_dwordx4 v4, s[4:7], s22 offen offset:0 nt lds
  s_waitcnt vmcnt(22)
  buffer_load_dwordx4 v5, s[4:7], s22 offen offset:1024 nt lds
  s_waitcnt vmcnt(22)
  buffer_load_dwordx4 v6, s[4:7], s22 offen offset:2048 nt lds
  s_waitcnt vmcnt(22)
  buffer_load_dwordx4 v7, s[4:7], s22 offen offset:3072 nt lds
  s_addk_i32 s22, 512
  s_addk_i32 m0, 4096
  s_waitcnt vmcnt(22)
  buffer_load_dwordx4 v4, s[4:7], s22 offen offset:0 nt lds
  s_waitcnt vmcnt(22)
  buffer_load_dwordx4 v5, s[4:7], s22 offen offset:1024 nt lds
  s_waitcnt vmcnt(22)
  buffer_load_dwordx4 v6, s[4:7], s22 offen offset:2048 nt lds
  s_waitcnt vmcnt(22)
  buffer_load_dwordx4 v7, s[4:7], s22 offen offset:3072 nt lds
  s_addk_i32 s22, 512
  s_addk_i32 m0, 4096
  s_waitcnt vmcnt(22)
  buffer_load_dwordx4 v4, s[4:7], s22 offen offset:0 nt lds
  s_waitcnt vmcnt(22)
  buffer_load_dwordx4 v5, s[4:7], s22 offen offset:1024 nt lds
  s_waitcnt vmcnt(22)
  buffer_load_dwordx4 v6, s[4:7], s22 offen offset:2048 nt lds
  s_waitcnt vmcnt(22)
  buffer_load_dwordx4 v7, s[4:7], s22 offen offset:3072 nt lds
  s_addk_i32 s22, 512
  s_addk_i32 m0, 4096
  s_waitcnt vmcnt(22)
  buffer_load_dwordx4 v4, s[4:7], s22 offen offset:0 nt lds
  s_waitcnt vmcnt(22)
  buffer_load_dwordx4 v5, s[4:7], s22 offen offset:1024 nt lds
  s_waitcnt vmcnt(22)
  buffer_load_dwordx4 v6, s[4:7], s22 offen offset:2048 nt lds
  s_waitcnt vmcnt(22)
  buffer_load_dwordx4 v7, s[4:7], s22 offen offset:3072 nt lds
  s_addk_i32 s22, 512
  s_addk_i32 m0, 4096
  s_waitcnt vmcnt(22)
  buffer_load_dwordx4 v4, s[4:7], s22 offen offset:0 nt lds
  s_waitcnt vmcnt(22)
  buffer_load_dwordx4 v5, s[4:7], s22 offen offset:1024 nt lds
  s_waitcnt vmcnt(22)
  buffer_load_dwordx4 v6, s[4:7], s22 offen offset:2048 nt lds
  s_barrier
  s_waitcnt vmcnt(22)
  buffer_load_dwordx4 v7, s[4:7], s22 offen offset:3072 nt lds
  s_addk_i32 s22, 512
  s_addk_i32 m0, 4096
  s_waitcnt vmcnt(22)
  buffer_load_dwordx4 v4, s[4:7], s22 offen offset:0 nt lds
  s_waitcnt vmcnt(22)
  buffer_load_dwordx4 v5, s[4:7], s22 offen offset:1024 nt lds
  s_waitcnt vmcnt(22)
  buffer_load_dwordx4 v6, s[4:7], s22 offen offset:2048 nt lds
  s_waitcnt vmcnt(22)
  buffer_load_dwordx4 v7, s[4:7], s22 offen offset:3072 nt lds
  s_addk_i32 s22, 512
  s_addk_i32 m0, 4096
  ds_read_b32 v13, v12
  s_waitcnt vmcnt(22)
  buffer_load_dwordx4 v4, s[4:7], s22 offen offset:0 nt lds
  s_waitcnt vmcnt(22)
  buffer_load_dwordx4 v5, s[4:7], s22 offen offset:1024 nt lds
  s_waitcnt vmcnt(22)
  buffer_load_dwordx4 v6, s[4:7], s22 offen offset:2048 nt lds
  s_waitcnt vmcnt(22)
  buffer_load_dwordx4 v7, s[4:7], s22 offen offset:3072 nt lds
  s_add_u32 s22, s22, 61952
  s_addk_i32 m0, 4096
  s_cmp_ge_u32 m0, 98304
  s_cselect_b32 m0, 0, m0
  s_add_u32 s21, s21, 1
  s_and_b32 s42, s21, 15
  s_cbranch_scc0 L_ld_swap
  s_cmp_eq_u32 s21, 30
  s_cbranch_scc1 L_ld_tail
  s_waitcnt lgkmcnt(0)
  v_readfirstlane_b32 s42, v13
  s_cmp_eq_u32 s42, 6
  s_cbranch_scc1 L_ld_v6
  s_branch L_ld_dispatch
L_touch2:
  s_branch L_touch5
L_ld_v1:
  s_waitcnt vmcnt(17)
  buffer_load_dwordx4 v4, s[4:7], s22 offen offset:0 nt lds
  s_waitcnt vmcnt(17)
  buffer_load_dwordx4 v5, s[4:7], s22 offen offset:1024 nt lds
  s_waitcnt vmcnt(17)
  buffer_load_dwordx4 v6, s[4:7], s22 offen offset:2048 nt lds
  s_waitcnt vmcnt(17)
  buffer_load_dwordx4 v7, s[4:7], s22 offen offset:3072 nt lds
  s_addk_i32 s22, 512
  s_addk_i32 m0, 4096
  s_waitcnt vmcnt(17)
  buffer_load_dwordx4 v4, s[4:7], s22 offen offset:0 nt lds
  s_waitcnt vmcnt(17)
  buffer_load_dwordx4 v5, s[4:7], s22 offen offset:1024 nt lds
  s_waitcnt vmcnt(17)
  buffer_load_dwordx4 v6, s[4:7], s22 offen offset:2048 nt lds
  s_waitcnt vmcnt(17)
  buffer_load_dwordx4 v7, s[4:7], s22 offen offset:3072 nt lds
  s_addk_i32 s22, 512
  s_addk_i32 m0, 4096
  s_waitcnt vmcnt(17)
  buffer_load_dwordx4 v4, s[4:7], s22 offen offset:0 nt lds
  s_waitcnt vmcnt(17)
  buffer_load_dwordx4 v5, s[4:7], s22 offen offset:1024 nt lds
  s_waitcnt vmcnt(17)
  buffer_load_dwordx4 v6, s[4:7], s22 offen offset:2048 nt lds
  s_waitcnt vmcnt(17)
  buffer_load_dwordx4 v7, s[4:7], s22 offen offset:3072 nt lds
  s_addk_i32 s22, 512
  s_addk_i32 m0, 4096
  s_waitcnt vmcnt(17)
  buffer_load_dwordx4 v4, s[4:7], s22 offen offset:0 nt lds
  s_waitcnt vmcnt(17)
  buffer_load_dwordx4 v5, s[4:7], s22 offen offset:1024 nt lds
  s_waitcnt vmcnt(17)
  buffer_load_dwordx4 v6, s[4:7], s22 offen offset:2048 nt lds
  s_waitcnt vmcnt(17)
  buffer_load_dwordx4 v7, s[4:7], s22 offen offset:3072 nt lds
  s_addk_i32 s22, 512
  s_addk_i32 m0, 4096
  s_waitcnt vmcnt(17)
  buffer_load_dwordx4 v4, s[4:7], s22 offen offset:0 nt lds
  s_waitcnt vmcnt(17)
  buffer_load_dwordx4 v5, s[4:7], s22 offen offset:1024 nt lds
  s_barrier
  s_waitcnt vmcnt(17)
  buffer_load_dwordx4 v6, s[4:7], s22 offen offset:2048 nt lds
  s_waitcnt vmcnt(17)
  buffer_load_dwordx4 v7, s[4:7], s22 offen offset:3072 nt lds
  s_addk_i32 s22, 512
  s_addk_i32 m0, 4096
  s_waitcnt vmcnt(17)
  buffer_load_dwordx4 v4, s[4:7], s22 offen offset:0 nt lds
  s_waitcnt vmcnt(17)
  buffer_load_dwordx4 v5, s[4:7], s22 offen offset:1024 nt lds
  s_waitcnt vmcnt(17)
  buffer_load_dwordx4 v6, s[4:7], s22 offen offset:2048 nt lds
  s_waitcnt vmcnt(17)
  buffer_load_dwordx4 v7, s[4:7], s22 offen offset:3072 nt lds
  s_addk_i32 s22, 512
  s_addk_i32 m0, 4096
  s_waitcnt vmcnt(17)
  buffer_load_dwordx4 v4, s[4:7], s22 offen offset:0 nt lds
  s_waitcnt vmcnt(17)
  buffer_load_dwordx4 v5, s[4:7], s22 offen offset:1024 nt lds
  s_waitcnt vmcnt(17)
  buffer_load_dwordx4 v6, s[4:7], s22 offen offset:2048 nt lds
  s_waitcnt vmcnt(17)
  buffer_load_dwordx4 v7, s[4:7], s22 offen offset:3072 nt lds
  s_addk_i32 s22, 512
  s_addk_i32 m0, 4096
  ds_read_b32 v13, v12
  s_waitcnt vmcnt(17)
  buffer_load_dwordx4 v4, s[4:7], s22 offen offset:0 nt lds
  s_waitcnt vmcnt(17)
  buffer_load_dwordx4 v5, s[4:7], s22 offen offset:1024 nt lds
  s_waitcnt vmcnt(17)
  buffer_load_dwordx4 v6, s[4:7], s22 offen offset:2048 nt lds
  s_waitcnt vmcnt(17)
  buffer_load_dwordx4 v7, s[4:7], s22 offen offset:3072 nt lds
  s_add_u32 s22, s22, 61952
  s_addk_i32 m0, 4096
  s_cmp_ge_u32 m0, 98304
  s_cselect_b32 m0, 0, m0
  s_add_u32 s21, s21, 1
  s_and_b32 s42, s21, 15
  s_cbranch_scc0 L_ld_swap
  s_cmp_eq_u32 s21, 30
  s_cbranch_scc1 L_ld_tail
  s_waitcnt lgkmcnt(0)
  v_readfirstlane_b32 s42, v13
  s_cmp_eq_u32 s42, 1
  s_cbranch_scc1 L_ld_v1
  s_branch L_ld_dispatch
L_ld_v7:
  s_waitcnt vmcnt(23)
  buffer_load_dwordx4 v4, s[4:7], s22 offen offset:0 nt lds
  s_waitcnt vmcnt(23)
  buffer_load_dwordx4 v5, s[4:7], s22 offen offset:1024 nt lds
  s_waitcnt vmcnt(23)
  buffer_load_dwordx4 v6, s[4:7], s22 offen offset:2048 nt lds
  s_waitcnt vmcnt(23)
  buffer_load_dwordx4 v7, s[4:7], s22 offen offset:3072 nt lds
  s_addk_i32 s22, 512
  s_addk_i32 m0, 4096
  s_waitcnt vmcnt(23)
  buffer_load_dwordx4 v4, s[4:7], s22 offen offset:0 nt lds
  s_waitcnt vmcnt(23)
  buffer_load_dwordx4 v5, s[4:7], s22 offen offset:1024 nt lds
  s_waitcnt vmcnt(23)
  buffer_load_dwordx4 v6, s[4:7], s22 offen offset:2048 nt lds
  s_waitcnt vmcnt(23)
  buffer_load_dwordx4 v7, s[4:7], s22 offen offset:3072 nt lds
  s_addk_i32 s22, 512
  s_addk_i32 m0, 4096
  s_waitcnt vmcnt(23)
  buffer_load_dwordx4 v4, s[4:7], s22 offen offset:0 nt lds
  s_waitcnt vmcnt(23)
  buffer_load_dwordx4 v5, s[4:7], s22 offen offset:1024 nt lds
  s_waitcnt vmcnt(23)
  buffer_load_dwordx4 v6, s[4:7], s22 offen offset:2048 nt lds
  s_waitcnt vmcnt(23)
  buffer_load_dwordx4 v7, s[4:7], s22 offen offset:3072 nt lds
  s_addk_i32 s22, 512
  s_addk_i32 m0, 4096
  s_waitcnt vmcnt(23)
  buffer_load_dwordx4 v4, s[4:7], s22 offen offset:0 nt lds
  s_waitcnt vmcnt(23)
  buffer_load_dwordx4 v5, s[4:7], s22 offen offset:1024 nt lds
  s_waitcnt vmcnt(23)
  buffer_load_dwordx4 v6, s[4:7], s22 offen offset:2048 nt lds
  s_waitcnt vmcnt(23)
  buffer_load_dwordx4 v7, s[4:7], s22 offen offset:3072 nt lds
  s_addk_i32 s22, 512
  s_addk_i32 m0, 4096
  s_waitcnt vmcnt(23)
  buffer_load_dwordx4 v4, s[4:7], s22 offen offset:0 nt lds
  s_waitcnt vmcnt(23)
  buffer_load_dwordx4 v5, s[4:7], s22 offen offset:1024 nt lds
  s_waitcnt vmcnt(23)
  buffer_load_dwordx4 v6, s[4:7], s22 offen offset:2048 nt lds
  s_waitcnt vmcnt(23)
  buffer_load_dwordx4 v7, s[4:7], s22 offen offset:3072 nt lds
  s_addk_i32 s22, 512
  s_addk_i32 m0, 4096
  s_waitcnt vmcnt(23)
  buffer_load_dwordx4 v4, s[4:7], s22 offen offset:0 nt lds
  s_waitcnt vmcnt(23)
  buffer_load_dwordx4 v5, s[4:7], s22 offen offset:1024 nt lds
  s_waitcnt vmcnt(23)
  buffer_load_dwordx4 v6, s[4:7], s22 offen offset:2048 nt lds
  s_waitcnt vmcnt(23)
  buffer_load_dwordx4 v7, s[4:7], s22 offen offset:3072 nt lds
  s_barrier
  s_addk_i32 s22, 512
  s_addk_i32 m0, 4096
  s_waitcnt vmcnt(23)
  buffer_load_dwordx4 v4, s[4:7], s22 offen offset:0 nt lds
  s_waitcnt vmcnt(23)
  buffer_load_dwordx4 v5, s[4:7], s22 offen offset:1024 nt lds
  s_waitcnt vmcnt(23)
  buffer_load_dwordx4 v6, s[4:7], s22 offen offset:2048 nt lds
  s_waitcnt vmcnt(23)
  buffer_load_dwordx4 v7, s[4:7], s22 offen offset:3072 nt lds
  s_addk_i32 s22, 512
  s_addk_i32 m0, 4096
  ds_read_b32 v13, v12
  s_waitcnt vmcnt(23)
  buffer_load_dwordx4 v4, s[4:7], s22 offen offset:0 nt lds
  s_waitcnt vmcnt(23)
  buffer_load_dwordx4 v5, s[4:7], s22 offen offset:1024 nt lds
  s_waitcnt vmcnt(23)
  buffer_load_dwordx4 v6, s[4:7], s22 offen offset:2048 nt lds
  s_waitcnt vmcnt(23)
  buffer_load_dwordx4 v7, s[4:7], s22 offen offset:3072 nt lds
  s_add_u32 s22, s22, 61952
  s_addk_i32 m0, 4096
  s_cmp_ge_u32 m0, 98304
  s_cselect_b32 m0, 0, m0
  s_add_u32 s21, s21, 1
  s_and_b32 s42, s21, 15
  s_cbranch_scc0 L_ld_swap
  s_cmp_eq_u32 s21, 30
  s_cbranch_scc1 L_ld_tail
  s_waitcnt lgkmcnt(0)
  v_readfirstlane_b32 s42, v13
  s_cmp_eq_u32 s42, 7
  s_cbranch_scc1 L_ld_v7
  s_branch L_ld_dispatch
L_touch3:
  s_branch L_touch6
L_ld_v0:
  s_waitcnt vmcnt(16)
  buffer_load_dwordx4 v4, s[4:7], s22 offen offset:0 nt lds
  s_waitcnt vmcnt(16)
  buffer_load_dwordx4 v5, s[4:7], s22 offen offset:1024 nt lds
  s_waitcnt vmcnt(16)
  buffer_load_dwordx4 v6, s[4:7], s22 offen offset:2048 nt lds
  s_waitcnt vmcnt(16)
  buffer_load_dwordx4 v7, s[4:7], s22 offen offset:3072 nt lds
  s_addk_i32 s22, 512
  s_addk_i32 m0, 4096
  s_waitcnt vmcnt(16)
  buffer_load_dwordx4 v4, s[4:7], s22 offen offset:0 nt lds
  s_waitcnt vmcnt(16)
  buffer_load_dwordx4 v5, s[4:7], s22 offen offset:1024 nt lds
  s_waitcnt vmcnt(16)
  buffer_load_dwordx4 v6, s[4:7], s22 offen offset:2048 nt lds
  s_waitcnt vmcnt(16)
  buffer_load_dwordx4 v7, s[4:7], s22 offen offset:3072 nt lds
  s_addk_i32 s22, 512
  s_addk_i32 m0, 4096
  s_waitcnt vmcnt(16)
  buffer_load_dwordx4 v4, s[4:7], s22 offen offset:0 nt lds
  s_waitcnt vmcnt(16)
  buffer_load_dwordx4 v5, s[4:7], s22 offen offset:1024 nt lds
  s_waitcnt vmcnt(16)
  buffer_load_dwordx4 v6, s[4:7], s22 offen offset:2048 nt lds
  s_waitcnt vmcnt(16)
  buffer_load_dwordx4 v7, s[4:7], s22 offen offset:3072 nt lds
  s_addk_i32 s22, 512
  s_addk_i32 m0, 4096
  s_waitcnt vmcnt(16)
  buffer_load_dwordx4 v4, s[4:7], s22 offen offset:0 nt lds
  s_waitcnt vmcnt(16)
  buffer_load_dwordx4 v5, s[4:7], s22 offen offset:1024 nt lds
  s_waitcnt vmcnt(16)
  buffer_load_dwordx4 v6, s[4:7], s22 offen offset:2048 nt lds
  s_waitcnt vmcnt(16)
  buffer_load_dwordx4 v7, s[4:7], s22 offen offset:3072 nt lds
  s_addk_i32 s22, 512
  s_addk_i32 m0, 4096
  s_waitcnt vmcnt(16)
  buffer_load_dwordx4 v4, s[4:7], s22 offen offset:0 nt lds
  s_barrier
  s_waitcnt vmcnt(16)
  buffer_load_dwordx4 v5, s[4:7], s22 offen offset:1024 nt lds
  s_waitcnt vmcnt(16)
  buffer_load_dwordx4 v6, s[4:7], s22 offen offset:2048 nt lds
  s_waitcnt vmcnt(16)
  buffer_load_dwordx4 v7, s[4:7], s22 offen offset:3072 nt lds
  s_addk_i32 s22, 512
  s_addk_i32 m0, 4096
  s_waitcnt vmcnt(16)
  buffer_load_dwordx4 v4, s[4:7], s22 offen offset:0 nt lds
  s_waitcnt vmcnt(16)
  buffer_load_dwordx4 v5, s[4:7], s22 offen offset:1024 nt lds
  s_waitcnt vmcnt(16)
  buffer_load_dwordx4 v6, s[4:7], s22 offen offset:2048 nt lds
  s_waitcnt vmcnt(16)
  buffer_load_dwordx4 v7, s[4:7], s22 offen offset:3072 nt lds
  s_addk_i32 s22, 512
  s_addk_i32 m0, 4096
  s_waitcnt vmcnt(16)
  buffer_load_dwordx4 v4, s[4:7], s22 offen offset:0 nt lds
  s_waitcnt vmcnt(16)
  buffer_load_dwordx4 v5, s[4:7], s22 offen offset:1024 nt lds
  s_waitcnt vmcnt(16)
  buffer_load_dwordx4 v6, s[4:7], s22 offen offset:2048 nt lds
  s_waitcnt vmcnt(16)
  buffer_load_dwordx4 v7, s[4:7], s22 offen offset:3072 nt lds
  s_addk_i32 s22, 512
  s_addk_i32 m0, 4096
  ds_read_b32 v13, v12
  s_waitcnt vmcnt(16)
  buffer_load_dwordx4 v4, s[4:7], s22 offen offset:0 nt lds
  s_waitcnt vmcnt(16)
  buffer_load_dwordx4 v5, s[4:7], s22 offen offset:1024 nt lds
  s_waitcnt vmcnt(16)
  buffer_load_dwordx4 v6, s[4:7], s22 offen offset:2048 nt lds
  s_waitcnt vmcnt(16)
  buffer_load_dwordx4 v7, s[4:7], s22 offen offset:3072 nt lds
  s_add_u32 s22, s22, 61952
  s_addk_i32 m0, 4096
  s_cmp_ge_u32 m0, 98304
  s_cselect_b32 m0, 0, m0
  s_add_u32 s21, s21, 1
  s_and_b32 s42, s21, 15
  s_cbranch_scc0 L_ld_swap
  s_cmp_eq_u32 s21, 30
  s_cbranch_scc1 L_ld_tail
  s_waitcnt lgkmcnt(0)
  v_readfirstlane_b32 s42, v13
  s_cmp_eq_u32 s42, 0
  s_cbranch_scc1 L_ld_v0
  s_branch L_ld_dispatch
L_ld_v8:
  s_waitcnt vmcnt(25)
  buffer_load_dwordx4 v4, s[4:7], s22 offen offset:0 nt lds
  s_waitcnt vmcnt(25)
  buffer_load_dwordx4 v5, s[4:7], s22 offen offset:1024 nt lds
  s_waitcnt vmcnt(25)
  buffer_load_dwordx4 v6, s[4:7], s22 offen offset:2048 nt lds
  s_waitcnt vmcnt(25)
  buffer_load_dwordx4 v7, s[4:7], s22 offen offset:3072 nt lds
  s_addk_i32 s22, 512
  s_addk_i32 m0, 4096
  s_waitcnt vmcnt(25)
  buffer_load_dwordx4 v4, s[4:7], s22 offen offset:0 nt lds
  s_waitcnt vmcnt(25)
  buffer_load_dwordx4 v5, s[4:7], s22 offen offset:1024 nt lds
  s_waitcnt vmcnt(25)
  buffer_load_dwordx4 v6, s[4:7], s22 offen offset:2048 nt lds
  s_waitcnt vmcnt(25)
  buffer_load_dwordx4 v7, s[4:7], s22 offen offset:3072 nt lds
  s_addk_i32 s22, 512
  s_addk_i32 m0, 4096
  s_waitcnt vmcnt(25)
  buffer_load_dwordx4 v4, s[4:7], s22 offen offset:0 nt lds
  s_waitcnt vmcnt(25)
  buffer_load_dwordx4 v5, s[4:7], s22 offen offset:1024 nt lds
  s_waitcnt vmcnt(25)
  buffer_load_dwordx4 v6, s[4:7], s22 offen offset:2048 nt lds
  s_waitcnt vmcnt(25)
  buffer_load_dwordx4 v7, s[4:7], s22 offen offset:3072 nt lds
  s_addk_i32 s22, 512
  s_addk_i32 m0, 4096
  s_waitcnt vmcnt(25)
  buffer_load_dwordx4 v4, s[4:7], s22 offen offset:0 nt lds
  s_waitcnt vmcnt(25)
  buffer_load_dwordx4 v5, s[4:7], s22 offen offset:1024 nt lds
  s_waitcnt vmcnt(25)
  buffer_load_dwordx4 v6, s[4:7], s22 offen offset:2048 nt lds
  s_waitcnt vmcnt(25)
  buffer_load_dwordx4 v7, s[4:7], s22 offen offset:3072 nt lds
  s_addk_i32 s22, 512
  s_addk_i32 m0, 4096
  s_waitcnt vmcnt(25)
  buffer_load_dwordx4 v4, s[4:7], s22 offen offset:0 nt lds
  s_waitcnt vmcnt(25)
  buffer_load_dwordx4 v5, s[4:7], s22 offen offset:1024 nt lds
  s_waitcnt vmcnt(25)
  buffer_load_dwordx4 v6, s[4:7], s22 offen offset:2048 nt lds
  s_waitcnt vmcnt(25)
  buffer_load_dwordx4 v7, s[4:7], s22 offen offset:3072 nt lds
  s_addk_i32 s22, 512
  s_addk_i32 m0, 4096
  s_waitcnt vmcnt(25)
  buffer_load_dwordx4 v4, s[4:7], s22 offen offset:0 nt lds
  s_waitcnt vmcnt(25)
  buffer_load_dwordx4 v5, s[4:7], s22 offen offset:1024 nt lds
  s_waitcnt vmcnt(25)
  buffer_load_dwordx4 v6, s[4:7], s22 offen offset:2048 nt lds
  s_waitcnt vmcnt(25)
  buffer_load_dwordx4 v7, s[4:7], s22 offen offset:3072 nt lds
  s_addk_i32 s22, 512
  s_addk_i32 m0, 4096
  s_waitcnt vmcnt(25)
  buffer_load_dwordx4 v4, s[4:7], s22 offen offset:0 nt lds
  s_waitcnt vmcnt(25)
  buffer_load_dwordx4 v5, s[4:7], s22 offen offset:1024 nt lds
  s_barrier
  s_waitcnt vmcnt(25)
  buffer_load_dwordx4 v6, s[4:7], s22 offen offset:2048 nt lds
  s_waitcnt vmcnt(25)
  buffer_load_dwordx4 v7, s[4:7], s22 offen offset:3072 nt lds
  s_addk_i32 s22, 512
  s_addk_i32 m0, 4096
  ds_read_b32 v13, v12
  s_waitcnt vmcnt(25)
  buffer_load_dwordx4 v4, s[4:7], s22 offen offset:0 nt lds
  s_waitcnt vmcnt(25)
  buffer_load_dwordx4 v5, s[4:7], s22 offen offset:1024 nt lds
  s_waitcnt vmcnt(25)
  buffer_load_dwordx4 v6, s[4:7], s22 offen offset:2048 nt lds
  s_waitcnt vmcnt(25)
  buffer_load_dwordx4 v7, s[4:7], s22 offen offset:3072 nt lds
  s_add_u32 s22, s22, 61952
  s_addk_i32 m0, 4096
  s_cmp_ge_u32 m0, 98304
  s_cselect_b32 m0, 0, m0
  s_add_u32 s21, s21, 1
  s_and_b32 s42, s21, 15
  s_cbranch_scc0 L_ld_swap
  s_cmp_eq_u32 s21, 30
  s_cbranch_scc1 L_ld_tail
  s_waitcnt lgkmcnt(0)
  v_readfirstlane_b32 s42, v13
  s_cmp_eq_u32 s42, 8
  s_cbranch_scc1 L_ld_v8
  s_branch L_ld_dispatch
L_touch4:
  s_branch L_storage
L_ld_tail:
  s_mov_b32 s23, s22
  s_waitcnt vmcnt(20)
  buffer_load_dwordx4 v24, s[4:7], s22 offen offset:0 nt lds
  s_waitcnt vmcnt(20)
  buffer_load_dwordx4 v25, s[4:7], s22 offen offset:1024 nt lds
  s_waitcnt vmcnt(20)
  buffer_load_dwordx4 v26, s[4:7], s22 offen offset:2048 nt lds
  s_waitcnt vmcnt(20)
  buffer_load_dwordx4 v27, s[4:7], s22 offen offset:3072 nt lds
  s_addk_i32 s22, 1024
  s_addk_i32 m0, 4096
  s_waitcnt vmcnt(20)
  buffer_load_dwordx4 v24, s[4:7], s22 offen offset:0 nt lds
  s_waitcnt vmcnt(20)
  buffer_load_dwordx4 v25, s[4:7], s22 offen offset:1024 nt lds
  s_waitcnt vmcnt(20)
  buffer_load_dwordx4 v26, s[4:7], s22 offen offset:2048 nt lds
  s_waitcnt vmcnt(20)
  buffer_load_dwordx4 v27, s[4:7], s22 offen offset:3072 nt lds
  s_addk_i32 s22, 1024
  s_addk_i32 m0, 4096
  s_waitcnt vmcnt(20)
  buffer_load_dwordx4 v24, s[4:7], s22 offen offset:0 nt lds
  s_waitcnt vmcnt(20)
  buffer_load_dwordx4 v25, s[4:7], s22 offen offset:1024 nt lds
  s_waitcnt vmcnt(20)
  buffer_load_dwordx4 v26, s[4:7], s22 offen offset:2048 nt lds
  s_waitcnt vmcnt(20)
  buffer_load_dwordx4 v27, s[4:7], s22 offen offset:3072 nt lds
  s_addk_i32 s22, 1024
  s_addk_i32 m0, 4096
  s_waitcnt vmcnt(20)
  buffer_load_dwordx4 v24, s[4:7], s22 offen offset:0 nt lds
  s_waitcnt vmcnt(20)
  buffer_load_dwordx4 v25, s[4:7], s22 offen offset:1024 nt lds
  s_waitcnt vmcnt(20)
  buffer_load_dwordx4 v26, s[4:7], s22 offen offset:2048 nt lds
  s_waitcnt vmcnt(20)
  buffer_load_dwordx4 v27, s[4:7], s22 offen offset:3072 nt lds
  s_add_u32 s22, s22, 62464
  s_addk_i32 m0, 4096
  s_waitcnt vmcnt(20)
  buffer_load_dwordx4 v24, s[4:7], s22 offen offset:0 nt lds
  s_waitcnt vmcnt(20)
  buffer_load_dwordx4 v25, s[4:7], s22 offen offset:1024 nt lds
  s_waitcnt vmcnt(20)
  buffer_load_dwordx4 v26, s[4:7], s22 offen offset:2048 nt lds
  s_waitcnt vmcnt(20)
  buffer_load_dwordx4 v27, s[4:7], s22 offen offset:3072 nt lds
  s_addk_i32 s22, 1024
  s_addk_i32 m0, 4096
  s_waitcnt vmcnt(20)
  buffer_load_dwordx4 v24, s[4:7], s22 offen offset:0 nt lds
  s_barrier
  s_waitcnt vmcnt(20)
  buffer_load_dwordx4 v25, s[4:7], s22 offen offset:1024 nt lds
  s_waitcnt vmcnt(20)
  buffer_load_dwordx4 v26, s[4:7], s22 offen offset:2048 nt lds
  s_waitcnt vmcnt(20)
  buffer_load_dwordx4 v27, s[4:7], s22 offen offset:3072 nt lds
  s_addk_i32 s22, 1024
  s_addk_i32 m0, 4096
  s_waitcnt vmcnt(20)
  buffer_load_dwordx4 v24, s[4:7], s22 offen offset:0 nt lds
  s_waitcnt vmcnt(20)
  buffer_load_dwordx4 v25, s[4:7], s22 offen offset:1024 nt lds
  s_waitcnt vmcnt(20)
  buffer_load_dwordx4 v26, s[4:7], s22 offen offset:2048 nt lds
  s_waitcnt vmcnt(20)
  buffer_load_dwordx4 v27, s[4:7], s22 offen offset:3072 nt lds
  s_addk_i32 s22, 1024
  s_addk_i32 m0, 4096
  s_waitcnt vmcnt(20)
  buffer_load_dwordx4 v24, s[4:7], s22 offen offset:0 nt lds
  s_waitcnt vmcnt(20)
  buffer_load_dwordx4 v25, s[4:7], s22 offen offset:1024 nt lds
  s_waitcnt vmcnt(20)
  buffer_load_dwordx4 v26, s[4:7], s22 offen offset:2048 nt lds
  s_waitcnt vmcnt(20)
  buffer_load_dwordx4 v27, s[4:7], s22 offen offset:3072 nt lds
  s_addk_i32 m0, 4096
  s_waitcnt vmcnt(20)
  buffer_load_dwordx4 v28, s[4:7], s23 offen offset:0 nt lds
  s_waitcnt vmcnt(20)
  buffer_load_dwordx4 v29, s[4:7], s23 offen offset:1024 nt lds
  s_waitcnt vmcnt(20)
  buffer_load_dwordx4 v30, s[4:7], s23 offen offset:2048 nt lds
  s_waitcnt vmcnt(20)
  buffer_load_dwordx4 v31, s[4:7], s23 offen offset:3072 nt lds
  s_addk_i32 s23, 1024
  s_addk_i32 m0, 4096
  s_waitcnt vmcnt(20)
  buffer_load_dwordx4 v28, s[4:7], s23 offen offset:0 nt lds
  s_barrier
  s_waitcnt vmcnt(20)
  buffer_load_dwordx4 v29, s[4:7], s23 offen offset:1024 nt lds
  s_waitcnt vmcnt(20)
  buffer_load_dwordx4 v30, s[4:7], s23 offen offset:2048 nt lds
  s_waitcnt vmcnt(20)
  buffer_load_dwordx4 v31, s[4:7], s23 offen offset:3072 nt lds
  s_addk_i32 s23, 1024
  s_addk_i32 m0, 4096
  s_waitcnt vmcnt(20)
  buffer_load_dwordx4 v28, s[4:7], s23 offen offset:0 nt lds
  s_waitcnt vmcnt(20)
  buffer_load_dwordx4 v29, s[4:7], s23 offen offset:1024 nt lds
  s_waitcnt vmcnt(20)
  buffer_load_dwordx4 v30, s[4:7], s23 offen offset:2048 nt lds
  s_waitcnt vmcnt(20)
  buffer_load_dwordx4 v31, s[4:7], s23 offen offset:3072 nt lds
  s_addk_i32 s23, 1024
  s_addk_i32 m0, 4096
  s_waitcnt vmcnt(20)
  buffer_load_dwordx4 v28, s[4:7], s23 offen offset:0 nt lds
  s_waitcnt vmcnt(20)
  buffer_load_dwordx4 v29, s[4:7], s23 offen offset:1024 nt lds
  s_waitcnt vmcnt(20)
  buffer_load_dwordx4 v30, s[4:7], s23 offen offset:2048 nt lds
  s_waitcnt vmcnt(20)
  buffer_load_dwordx4 v31, s[4:7], s23 offen offset:3072 nt lds
  s_add_u32 s23, s23, 62464
  s_addk_i32 m0, 4096
  s_waitcnt vmcnt(20)
  buffer_load_dwordx4 v28, s[4:7], s23 offen offset:0 nt lds
  s_waitcnt vmcnt(20)
  buffer_load_dwordx4 v29, s[4:7], s23 offen offset:1024 nt lds
  s_waitcnt vmcnt(20)
  buffer_load_dwordx4 v30, s[4:7], s23 offen offset:2048 nt lds
  s_waitcnt vmcnt(20)
  buffer_load_dwordx4 v31, s[4:7], s23 offen offset:3072 nt lds
  s_addk_i32 s23, 1024
  s_addk_i32 m0, 4096
  s_waitcnt vmcnt(20)
  buffer_load_dwordx4 v28, s[4:7], s23 offen offset:0 nt lds
  s_barrier
  s_waitcnt vmcnt(20)
  buffer_load_dwordx4 v29, s[4:7], s23 offen offset:1024 nt lds
  s_waitcnt vmcnt(20)
  buffer_load_dwordx4 v30, s[4:7], s23 offen offset:2048 nt lds
  s_waitcnt vmcnt(20)
  buffer_load_dwordx4 v31, s[4:7], s23 offen offset:3072 nt lds
  s_addk_i32 s23, 1024
  s_addk_i32 m0, 4096
  s_waitcnt vmcnt(20)
  buffer_load_dwordx4 v28, s[4:7], s23 offen offset:0 nt lds
  s_waitcnt vmcnt(20)
  buffer_load_dwordx4 v29, s[4:7], s23 offen offset:1024 nt lds
  s_waitcnt vmcnt(20)
  buffer_load_dwordx4 v30, s[4:7], s23 offen offset:2048 nt lds
  s_waitcnt vmcnt(20)
  buffer_load_dwordx4 v31, s[4:7], s23 offen offset:3072 nt lds
  s_addk_i32 s23, 1024
  s_addk_i32 m0, 4096
  s_waitcnt vmcnt(20)
  buffer_load_dwordx4 v28, s[4:7], s23 offen offset:0 nt lds
  s_waitcnt vmcnt(20)
  buffer_load_dwordx4 v29, s[4:7], s23 offen offset:1024 nt lds
  s_waitcnt vmcnt(20)
  buffer_load_dwordx4 v30, s[4:7], s23 offen offset:2048 nt lds
  s_waitcnt vmcnt(20)
  buffer_load_dwordx4 v31, s[4:7], s23 offen offset:3072 nt lds
  buffer_load_dword v16, v14, s[12:15], s66 offen nt
  s_waitcnt vmcnt(17)
  s_barrier
  s_waitcnt vmcnt(9)
  s_barrier
  s_waitcnt vmcnt(5)
  s_barrier
  s_waitcnt vmcnt(1)
  s_barrier
  s_endpgm
.p2align 12
L_compute:
  s_sub_u32 s20, s20, 1
  v_and_b32 v242, 63, v0
  v_and_b32 v2, 15, v0
  v_bfe_u32 v3, v0, 4, 2
  s_mov_b32 s14, 0x200000
  s_mov_b32 s15, 0x20000
  s_mov_b32 s18, 16777216
  s_mov_b32 s19, 0x20000
  s_lshl_b32 s42, s40, 2
  s_add_u32 s42, s42, s20
  s_lshl_b32 s69, s42, 12
  s_lshl_b32 s65, s42, 9
  s_add_u32 s65, s65, 5242880
  s_lshl_b32 s42, s41, 7
  s_add_u32 s80, s65, s42
  s_xor_b32 s81, s80, 128
  v_xor_b32 v231, v2, v3
  v_lshlrev_b32 v232, 8, v3
  v_lshl_add_u32 v234, v231, 4, v232
  v_xor_b32 v235, 64, v234
  v_xor_b32 v236, 128, v234
  v_xor_b32 v237, 192, v234
  s_lshl_b32 s74, s20, 12
  s_add_u32 s74, s74, 98304
  s_mov_b32 m0, s74
  v_mov_b32 v244, 0
  v_min_u32 v247, 32, v242
  v_lshlrev_b32 v247, 2, v247
  s_getreg_b32 s77, hwreg(HW_REG_XCC_ID, 0, 4)
  s_mul_i32 s78, s77, 4352
  s_add_u32 s78, s78, 7340032
  s_lshr_b32 s79, s2, 3
  s_mul_i32 s73, s79, 4352
  s_add_u32 s73, s73, 6291456
  s_cmp_eq_u32 s20, 1
  s_cselect_b32 s71, 1, 0
  s_waitcnt lgkmcnt(0)
  s_mov_b64 s[16:17], s[38:39]
  s_mov_b64 s[12:13], s[28:29]
  buffer_load_dwordx4 v[248:251], v244, s[16:19], s65 offen offset:256 sc1
  buffer_load_dword v255, v244, s[16:19], s81 offen sc1
  s_cbranch_scc0 L_nobase
  buffer_load_dword v246, v247, s[16:19], s78 offen sc1
  s_cmp_gt_u32 s79, 11
  s_cbranch_scc1 L_nobase
  buffer_load_dword v253, v244, s[16:19], s73 offen
L_nobase:
  buffer_load_dwordx4 v234, s[12:15], s69 offen offset:0 nt lds
  buffer_load_dwordx4 v235, s[12:15], s69 offen offset:1024 nt lds
  buffer_load_dwordx4 v236, s[12:15], s69 offen offset:2048 nt lds
  buffer_load_dwordx4 v237, s[12:15], s69 offen offset:3072 nt lds
  s_mov_b32 s62, 256
  s_mov_b32 s63, 0x20000
  s_mov_b32 s60, s36
  s_mov_b32 s61, s37
  s_add_u32 s66, s69, s42
  s_xor_b32 s67, s66, 128
  v_lshlrev_b32 v230, 8, v2
  v_bfe_u32 v252, v0, 3, 3
  v_lshlrev_b32 v252, 8, v252
  v_and_b32 v1, 7, v0
  v_lshl_add_u32 v252, v1, 4, v252
  s_or_b32 s77, s77, 16
  s_mul_i32 s72, s79, 2
  s_add_u32 s72, s72, 1
  s_cmp_le_u32 s72, 23
  s_cselect_b32 s72, s72, 64
  v_mov_b32 v233, 151556
  v_mov_b32 v232, 4
  ds_write_b32 v233, v232
  s_and_b32 s70, s40, 3
  s_lshl_b32 s70, s70, 3
  s_and_b32 s76, s40, 0x7c
  v_xor_b32 v233, 0, v231
  v_lshl_add_u32 v216, v233, 4, v230
  v_xor_b32 v233, 4, v231
  v_lshl_add_u32 v217, v233, 4, v230
  v_xor_b32 v233, 8, v231
  v_lshl_add_u32 v218, v233, 4, v230
  v_xor_b32 v233, 12, v231
  v_lshl_add_u32 v219, v233, 4, v230
  s_lshl_b32 s42, s41, 3
  s_xor_b32 s42, s42, 8
  v_bfe_u32 v230, v0, 2, 4
  v_and_b32 v231, 7, v230
  v_lshlrev_b32 v231, 1, v231
  v_xor_b32 v231, s42, v231
  v_lshlrev_b32 v230, 8, v230
  v_and_b32 v233, 3, v0
  v_lshl_add_u32 v230, v233, 3, v230
  v_xor_b32 v233, 0, v231
  v_lshl_add_u32 v220, v233, 4, v230
  v_xor_b32 v233, 2, v231
  v_lshl_add_u32 v221, v233, 4, v230
  v_xor_b32 v233, 4, v231
  v_lshl_add_u32 v222, v233, 4, v230
  v_xor_b32 v233, 6, v231
  v_lshl_add_u32 v223, v233, 4, v230
  v_xor_b32 v233, 8, v231
  v_lshl_add_u32 v224, v233, 4, v230
  v_xor_b32 v233, 10, v231
  v_lshl_add_u32 v225, v233, 4, v230
  v_xor_b32 v233, 12, v231
  v_lshl_add_u32 v226, v233, 4, v230
  v_xor_b32 v233, 14, v231
  v_lshl_add_u32 v227, v233, 4, v230
  v_mov_b64 v[20:21], 0
  v_mov_b64 v[22:23], 0
  v_mov_b64 v[24:25], 0
  v_mov_b64 v[26:27], 0
  v_mov_b64 v[28:29], 0
  v_mov_b64 v[30:31], 0
  v_mov_b64 v[32:33], 0
  v_mov_b64 v[34:35], 0
  v_mov_b64 v[36:37], 0
  v_mov_b64 v[38:39], 0
  v_mov_b64 v[40:41], 0
  v_mov_b64 v[42:43], 0
  v_mov_b64 v[44:45], 0
  v_mov_b64 v[46:47], 0
  v_mov_b64 v[48:49], 0
  v_mov_b64 v[50:51], 0
  v_mov_b32 v228, 0xff800000
  v_mov_b32 v229, 0
  v_mov_b32 v245, 0
  v_lshlrev_b32 v240, 3, v2
  v_lshl_add_u32 v239, v242, 4, s74
  s_lshl_b32 s42, s20, 10
  s_add_u32 s42, s42, 147456
  v_lshl_add_u32 v213, v2, 2, s42
  s_mov_b32 s26, 0x3e0293ee
  s_mov_b32 s27, s26
  s_mov_b32 s25, 0
  s_lshl_b32 s87, s79, 4
  s_mov_b32 s21, 0
  s_cmp_eq_u32 s20, 0
  s_cselect_b32 s64, 5, 17
  s_lshl_b32 s42, s41, 2
  s_add_u32 s82, s65, s42
  s_xor_b32 s83, s82, 4
  v_add_u32 v234, s74, v216
  v_add_u32 v235, s74, v217
  v_add_u32 v236, s74, v218
  v_add_u32 v237, s74, v219
  s_waitcnt vmcnt(0)
  ds_read_b128 v[4:7], v234
  ds_read_b128 v[8:11], v235
  ds_read_b128 v[12:15], v236
  ds_read_b128 v[16:19], v237
  s_mov_b32 s12, s34
  s_mov_b32 s13, s35
  s_waitcnt lgkmcnt(0)
  s_branch L_loop
L_ctl:
  v_sub_u32 v230, v245, v246
  s_add_u32 s42, s21, 1
  v_add_u32 v231, s42, v246
  s_lshl_b64 exec, 1, s79
  buffer_store_dword v231, v247, s[16:19], s78 offen
  s_sub_u32 s42, s21, s72
  s_cmp_eq_u32 s42, 0
  s_cbranch_scc0 L_ctl_nolead
  s_lshl_b64 exec, 1, 32
  v_mov_b32 v254, 1
  buffer_atomic_add v254, v244, s[16:19], s73 offen sc0 sc1
L_ctl_nolead:
  s_mov_b64 exec, -1
  buffer_load_dword v245, v247, s[16:19], s78 offen sc1
  s_cmp_lt_u32 s21, 2
  s_cbranch_scc1 L_ctl_ret
  v_cmp_ne_u32 vcc, 0, v230
  v_readlane_b32 s44, v230, 32
  v_add_u32_dpp v230, v230, v230 row_shr:1 row_mask:0xf bank_mask:0xf bound_ctrl:1
  s_nop 1
  v_add_u32_dpp v230, v230, v230 row_shr:2 row_mask:0xf bank_mask:0xf bound_ctrl:1
  s_nop 1
  v_add_u32_dpp v230, v230, v230 row_shr:4 row_mask:0xf bank_mask:0xf bound_ctrl:1
  s_nop 1
  v_add_u32_dpp v230, v230, v230 row_shr:8 row_mask:0xf bank_mask:0xf bound_ctrl:1
  s_cmp_eq_u32 vcc_lo, -1
  s_cbranch_scc0 L_ctl_end
  v_readlane_b32 s42, v230, 15
  v_readlane_b32 s43, v230, 31
  s_max_i32 s44, s44, -160
  s_min_i32 s44, s44, 160
  s_add_u32 s42, s42, s43
  s_lshl_b32 s43, s21, 5
  s_sub_i32 s43, s42, s43
  s_add_i32 s43, s43, 16
  s_max_i32 s43, s43, -128
  s_min_i32 s43, s43, 128
  s_sub_u32 s42, s21, s72
  s_cmp_eq_u32 s42, 1
  s_cbranch_scc0 L_ctl_norank
  s_mul_i32 s42, s43, 5
  s_add_i32 s42, s42, 112
  s_lshl_b64 exec, 1, 32
  v_sub_u32 v254, v254, v253
  v_lshl_add_u32 v254, v254, 5, v246
  v_subrev_u32 v254, s42, v254
  buffer_store_dword v254, v247, s[16:19], s78 offen
  s_mov_b64 exec, -1
L_ctl_norank:
  s_mul_i32 s43, s43, 40
  s_mul_i32 s42, s21, 10
  s_sub_i32 s42, 245, s42
  s_max_i32 s42, s42, 125
  s_mul_i32 s44, s44, s42
  s_ashr_i32 s44, s44, 4
  s_add_i32 s43, s43, s44
  s_add_i32 s43, s43, 1843
  s_add_i32 s43, s43, s87
  s_and_b32 s87, s43, 511
  s_ashr_i32 s43, s43, 9
  s_max_i32 s43, s43, 0
  s_min_i32 s43, s43, 8
  v_mov_b32 v230, s43
  v_mov_b32 v232, 151556
  ds_write_b32 v232, v230
  s_waitcnt lgkmcnt(0)
L_ctl_end:
  s_cmp_lt_u32 s21, 27
  s_cselect_b32 s71, s71, 0
  s_branch L_ctl_ret
L_loop:
  s_cmp_lg_u32 s71, 0
  s_barrier
  s_waitcnt vmcnt(0)
  s_cbranch_scc1 L_ctl
L_ctl_ret:
  s_cmp_eq_u32 s21, s64
  s_cbranch_scc1 L_hook
L_hook_ret:
  s_bitcmp1_b32 s21, 4
  s_cbranch_scc1 L_vbody
  ds_read_b128 v[84:87], v216 offset:0
  ds_read_b128 v[88:91], v217 offset:0
  s_add_u32 s25, s25, 1
  s_cmp_eq_u32 s25, 3
  ds_read_b128 v[92:95], v218 offset:0
  s_cselect_b32 s25, 0, s25
  s_mov_b32 s24, 32768
  ds_read_b128 v[96:99], v219 offset:0
  s_cmov_b32 s24, -65536
  ds_read_b128 v[100:103], v216 offset:4096
  ds_read_b128 v[104:107], v217 offset:4096
  ds_read_b128 v[108:111], v218 offset:4096
  ds_read_b128 v[112:115], v219 offset:4096
  s_waitcnt lgkmcnt(4)
  v_mfma_f32_16x16x32_bf16 v[52:55], v[84:87], v[4:7], 0
  ds_read_b128 v[116:119], v216 offset:8192
  v_mfma_f32_16x16x32_bf16 v[52:55], v[88:91], v[8:11], v[52:55]
  ds_read_b128 v[120:123], v217 offset:8192
  v_mfma_f32_16x16x32_bf16 v[52:55], v[92:95], v[12:15], v[52:55]
  ds_read_b128 v[124:127], v218 offset:8192
  v_mfma_f32_16x16x32_bf16 v[52:55], v[96:99], v[16:19], v[52:55]
  ds_read_b128 v[128:131], v219 offset:8192
  s_waitcnt lgkmcnt(4)
  v_mfma_f32_16x16x32_bf16 v[56:59], v[100:103], v[4:7], 0
  ds_read_b128 v[132:135], v216 offset:12288
  v_mfma_f32_16x16x32_bf16 v[56:59], v[104:107], v[8:11], v[56:59]
  ds_read_b128 v[136:139], v217 offset:12288
  v_mfma_f32_16x16x32_bf16 v[56:59], v[108:111], v[12:15], v[56:59]
  ds_read_b128 v[140:143], v218 offset:12288
  v_mfma_f32_16x16x32_bf16 v[56:59], v[112:115], v[16:19], v[56:59]
  ds_read_b128 v[144:147], v219 offset:12288
  s_waitcnt lgkmcnt(4)
  v_mfma_f32_16x16x32_bf16 v[60:63], v[116:119], v[4:7], 0
  ds_read_b128 v[84:87], v216 offset:16384
  v_mfma_f32_16x16x32_bf16 v[60:63], v[120:123], v[8:11], v[60:63]
  ds_read_b128 v[88:91], v217 offset:16384
  v_max3_f32 v232, v52, v53, v54
  v_mfma_f32_16x16x32_bf16 v[60:63], v[124:127], v[12:15], v[60:63]
  ds_read_b128 v[92:95], v218 offset:16384
  v_mfma_f32_16x16x32_bf16 v[60:63], v[128:131], v[16:19], v[60:63]
  ds_read_b128 v[96:99], v219 offset:16384
  s_waitcnt lgkmcnt(4)
  v_mfma_f32_16x16x32_bf16 v[64:67], v[132:135], v[4:7], 0
  ds_read_b128 v[100:103], v216 offset:20480
  v_mfma_f32_16x16x32_bf16 v[64:67], v[136:139], v[8:11], v[64:67]
  ds_read_b128 v[104:107], v217 offset:20480
  v_max3_f32 v232, v232, v55, v56
  v_mfma_f32_16x16x32_bf16 v[64:67], v[140:143], v[12:15], v[64:67]
  ds_read_b128 v[108:111], v218 offset:20480
  v_mfma_f32_16x16x32_bf16 v[64:67], v[144:147], v[16:19], v[64:67]
  ds_read_b128 v[112:115], v219 offset:20480
  v_max3_f32 v232, v232, v57, v58
  s_waitcnt lgkmcnt(4)
  v_mfma_f32_16x16x32_bf16 v[68:71], v[84:87], v[4:7], 0
  ds_read_b128 v[116:119], v216 offset:24576
  v_mfma_f32_16x16x32_bf16 v[68:71], v[88:91], v[8:11], v[68:71]
  ds_read_b128 v[120:123], v217 offset:24576
  v_max3_f32 v232, v232, v59, v60
  v_mfma_f32_16x16x32_bf16 v[68:71], v[92:95], v[12:15], v[68:71]
  ds_read_b128 v[124:127], v218 offset:24576
  v_mfma_f32_16x16x32_bf16 v[68:71], v[96:99], v[16:19], v[68:71]
  ds_read_b128 v[128:131], v219 offset:24576
  v_max3_f32 v232, v232, v61, v62
  s_waitcnt lgkmcnt(4)
  v_mfma_f32_16x16x32_bf16 v[72:75], v[100:103], v[4:7], 0
  ds_read_b128 v[132:135], v216 offset:28672
  v_mfma_f32_16x16x32_bf16 v[72:75], v[104:107], v[8:11], v[72:75]
  ds_read_b128 v[136:139], v217 offset:28672
  v_max3_f32 v232, v232, v63, v64
  v_mfma_f32_16x16x32_bf16 v[72:75], v[108:111], v[12:15], v[72:75]
  ds_read_b128 v[140:143], v218 offset:28672
  v_mfma_f32_16x16x32_bf16 v[72:75], v[112:115], v[16:19], v[72:75]
  ds_read_b128 v[144:147], v219 offset:28672
  v_max3_f32 v232, v232, v65, v66
  s_waitcnt lgkmcnt(4)
  v_mfma_f32_16x16x32_bf16 v[76:79], v[116:119], v[4:7], 0
  v_add_u32 v220, s24, v220
  v_mfma_f32_16x16x32_bf16 v[76:79], v[120:123], v[8:11], v[76:79]
  v_add_u32 v221, s24, v221
  v_max3_f32 v232, v232, v67, v68
  v_mfma_f32_16x16x32_bf16 v[76:79], v[124:127], v[12:15], v[76:79]
  v_add_u32 v222, s24, v222
  v_mfma_f32_16x16x32_bf16 v[76:79], v[128:131], v[16:19], v[76:79]
  v_add_u32 v223, s24, v223
  v_max3_f32 v232, v232, v69, v70
  s_waitcnt lgkmcnt(0)
  v_mfma_f32_16x16x32_bf16 v[80:83], v[132:135], v[4:7], 0
  v_add_u32 v224, s24, v224
  v_mfma_f32_16x16x32_bf16 v[80:83], v[136:139], v[8:11], v[80:83]
  v_add_u32 v225, s24, v225
  v_max3_f32 v232, v232, v71, v72
  v_mfma_f32_16x16x32_bf16 v[80:83], v[140:143], v[12:15], v[80:83]
  v_add_u32 v226, s24, v226
  v_mfma_f32_16x16x32_bf16 v[80:83], v[144:147], v[16:19], v[80:83]
  v_add_u32 v227, s24, v227
  v_max3_f32 v232, v232, v73, v74
  v_add_u32 v216, s24, v216
  v_add_u32 v217, s24, v217
  v_add_u32 v218, s24, v218
  v_add_u32 v219, s24, v219
  v_max3_f32 v232, v232, v75, v76
  v_max3_f32 v232, v232, v77, v78
  s_nop 2
  v_max3_f32 v232, v232, v79, v80
  v_max3_f32 v232, v232, v81, v82
  v_max_f32 v230, v232, v83
  v_max_f32 v231, v232, v83
  s_nop 1
  v_permlane32_swap_b32 v230, v231
  v_max_f32 v232, v230, v231
  v_max_f32 v231, v230, v231
  s_nop 1
  v_permlane16_swap_b32 v232, v231
  v_max_f32 v232, v232, v231
  v_mul_f32 v232, s26, v232
  v_max_f32 v232, v232, v228
  v_sub_f32 v212, v228, v232
  v_mov_b32 v228, v232
  v_exp_f32 v212, v212
  v_pk_fma_f32 v[52:53], v[52:53], s[26:27], v[232:233] op_sel_hi:[1,1,0] neg_lo:[0,0,1] neg_hi:[0,0,1]
  v_pk_fma_f32 v[54:55], v[54:55], s[26:27], v[232:233] op_sel_hi:[1,1,0] neg_lo:[0,0,1] neg_hi:[0,0,1]
  v_pk_fma_f32 v[56:57], v[56:57], s[26:27], v[232:233] op_sel_hi:[1,1,0] neg_lo:[0,0,1] neg_hi:[0,0,1]
  v_pk_fma_f32 v[58:59], v[58:59], s[26:27], v[232:233] op_sel_hi:[1,1,0] neg_lo:[0,0,1] neg_hi:[0,0,1]
  v_pk_fma_f32 v[60:61], v[60:61], s[26:27], v[232:233] op_sel_hi:[1,1,0] neg_lo:[0,0,1] neg_hi:[0,0,1]
  v_pk_fma_f32 v[62:63], v[62:63], s[26:27], v[232:233] op_sel_hi:[1,1,0] neg_lo:[0,0,1] neg_hi:[0,0,1]
  v_pk_fma_f32 v[64:65], v[64:65], s[26:27], v[232:233] op_sel_hi:[1,1,0] neg_lo:[0,0,1] neg_hi:[0,0,1]
  v_pk_fma_f32 v[66:67], v[66:67], s[26:27], v[232:233] op_sel_hi:[1,1,0] neg_lo:[0,0,1] neg_hi:[0,0,1]
  v_pk_fma_f32 v[68:69], v[68:69], s[26:27], v[232:233] op_sel_hi:[1,1,0] neg_lo:[0,0,1] neg_hi:[0,0,1]
  v_pk_fma_f32 v[70:71], v[70:71], s[26:27], v[232:233] op_sel_hi:[1,1,0] neg_lo:[0,0,1] neg_hi:[0,0,1]
  v_pk_fma_f32 v[72:73], v[72:73], s[26:27], v[232:233] op_sel_hi:[1,1,0] neg_lo:[0,0,1] neg_hi:[0,0,1]
  v_pk_fma_f32 v[74:75], v[74:75], s[26:27], v[232:233] op_sel_hi:[1,1,0] neg_lo:[0,0,1] neg_hi:[0,0,1]
  v_pk_fma_f32 v[76:77], v[76:77], s[26:27], v[232:233] op_sel_hi:[1,1,0] neg_lo:[0,0,1] neg_hi:[0,0,1]
  v_pk_fma_f32 v[78:79], v[78:79], s[26:27], v[232:233] op_sel_hi:[1,1,0] neg_lo:[0,0,1] neg_hi:[0,0,1]
  v_pk_fma_f32 v[80:81], v[80:81], s[26:27], v[232:233] op_sel_hi:[1,1,0] neg_lo:[0,0,1] neg_hi:[0,0,1]
  v_pk_fma_f32 v[82:83], v[82:83], s[26:27], v[232:233] op_sel_hi:[1,1,0] neg_lo:[0,0,1] neg_hi:[0,0,1]
  v_exp_f32 v52, v52
  v_exp_f32 v53, v53
  v_exp_f32 v54, v54
  v_exp_f32 v55, v55
  v_exp_f32 v56, v56
  v_exp_f32 v57, v57
  v_exp_f32 v58, v58
  v_exp_f32 v59, v59
  v_exp_f32 v60, v60
  v_exp_f32 v61, v61
  v_exp_f32 v62, v62
  v_exp_f32 v63, v63
  v_exp_f32 v64, v64
  v_exp_f32 v65, v65
  v_exp_f32 v66, v66
  v_exp_f32 v67, v67
  v_exp_f32 v68, v68
  v_exp_f32 v69, v69
  v_exp_f32 v70, v70
  v_exp_f32 v71, v71
  v_exp_f32 v72, v72
  v_exp_f32 v73, v73
  v_exp_f32 v74, v74
  v_exp_f32 v75, v75
  v_exp_f32 v76, v76
  v_exp_f32 v77, v77
  v_exp_f32 v78, v78
  v_exp_f32 v79, v79
  v_exp_f32 v80, v80
  v_exp_f32 v81, v81
  v_exp_f32 v82, v82
  v_exp_f32 v83, v83
  v_cvt_pk_bf16_f32 v84, v52, v53
  v_cvt_pk_bf16_f32 v85, v54, v55
  v_cvt_pk_bf16_f32 v86, v56, v57
  v_cvt_pk_bf16_f32 v87, v58, v59
  v_cvt_pk_bf16_f32 v88, v60, v61
  v_cvt_pk_bf16_f32 v89, v62, v63
  v_cvt_pk_bf16_f32 v90, v64, v65
  v_cvt_pk_bf16_f32 v91, v66, v67
  v_cvt_pk_bf16_f32 v92, v68, v69
  v_cvt_pk_bf16_f32 v93, v70, v71
  v_cvt_pk_bf16_f32 v94, v72, v73
  v_cvt_pk_bf16_f32 v95, v74, v75
  v_cvt_pk_bf16_f32 v96, v76, v77
  v_cvt_pk_bf16_f32 v97, v78, v79
  v_cvt_pk_bf16_f32 v98, v80, v81
  v_cvt_pk_bf16_f32 v99, v82, v83
  v_pk_add_f32 v[52:53], v[52:53], v[68:69]
  v_pk_add_f32 v[54:55], v[54:55], v[70:71]
  v_pk_add_f32 v[56:57], v[56:57], v[72:73]
  v_pk_add_f32 v[58:59], v[58:59], v[74:75]
  v_pk_add_f32 v[60:61], v[60:61], v[76:77]
  v_pk_add_f32 v[62:63], v[62:63], v[78:79]
  v_pk_add_f32 v[64:65], v[64:65], v[80:81]
  v_pk_add_f32 v[66:67], v[66:67], v[82:83]
  v_pk_add_f32 v[52:53], v[52:53], v[60:61]
  v_pk_add_f32 v[54:55], v[54:55], v[62:63]
  v_pk_add_f32 v[56:57], v[56:57], v[64:65]
  v_pk_add_f32 v[58:59], v[58:59], v[66:67]
  v_pk_add_f32 v[52:53], v[52:53], v[56:57]
  v_pk_add_f32 v[54:55], v[54:55], v[58:59]
  v_pk_add_f32 v[52:53], v[52:53], v[54:55]
  v_add_f32 v52, v52, v53
  v_fma_f32 v229, v229, v212, v52
  ds_write_b32 v213, v212
  v_add_u32 v213, 64, v213
  s_add_u32 s21, s21, 1
  s_cmp_gt_u32 s21, 4
  s_cbranch_scc1 L_park2
  v_mov_b64 v[148:149], v[164:165]
  v_mov_b64 v[150:151], v[166:167]
  v_mov_b64 v[152:153], v[168:169]
  v_mov_b64 v[154:155], v[170:171]
  v_mov_b64 v[156:157], v[172:173]
  v_mov_b64 v[158:159], v[174:175]
  v_mov_b64 v[160:161], v[176:177]
  v_mov_b64 v[162:163], v[178:179]
  v_mov_b64 v[164:165], v[180:181]
  v_mov_b64 v[166:167], v[182:183]
  v_mov_b64 v[168:169], v[184:185]
  v_mov_b64 v[170:171], v[186:187]
  v_mov_b64 v[172:173], v[188:189]
  v_mov_b64 v[174:175], v[190:191]
  v_mov_b64 v[176:177], v[192:193]
  v_mov_b64 v[178:179], v[194:195]
  v_mov_b64 v[180:181], v[196:197]
  v_mov_b64 v[182:183], v[198:199]
  v_mov_b64 v[184:185], v[200:201]
  v_mov_b64 v[186:187], v[202:203]
  v_mov_b64 v[188:189], v[204:205]
  v_mov_b64 v[190:191], v[206:207]
  v_mov_b64 v[192:193], v[208:209]
  v_mov_b64 v[194:195], v[210:211]
  v_mov_b64 v[196:197], v[84:85]
  v_mov_b64 v[198:199], v[86:87]
  v_mov_b64 v[200:201], v[88:89]
  v_mov_b64 v[202:203], v[90:91]
  v_mov_b64 v[204:205], v[92:93]
  v_mov_b64 v[206:207], v[94:95]
  v_mov_b64 v[208:209], v[96:97]
  v_mov_b64 v[210:211], v[98:99]
  s_waitcnt lgkmcnt(0)
  s_branch L_loop
L_park2:
  s_cmp_eq_u32 s21, 16
  s_cbranch_scc1 L_park3
  s_and_b32 s42, s21, 1
  s_add_u32 s42, s42, 1
  s_cmp_eq_u32 s21, 5
  s_cmov_b32 s42, 0
  s_lshl_b32 s42, s42, 14
  v_add_u32 v230, s42, v239
  ds_write_b128 v230, v[84:87] offset:0
  ds_write_b128 v230, v[88:91] offset:1024
  ds_write_b128 v230, v[92:95] offset:2048
  ds_write_b128 v230, v[96:99] offset:3072
  s_waitcnt lgkmcnt(0)
  s_branch L_loop
L_park3:
  v_subrev_u32 v213, 1024, v213
  ds_read_b32 v212, v213
  v_mov_b64 v[52:53], v[84:85]
  v_mov_b64 v[54:55], v[86:87]
  v_mov_b64 v[56:57], v[88:89]
  v_mov_b64 v[58:59], v[90:91]
  v_mov_b64 v[60:61], v[92:93]
  v_mov_b64 v[62:63], v[94:95]
  v_mov_b64 v[64:65], v[96:97]
  v_mov_b64 v[66:67], v[98:99]
  s_waitcnt lgkmcnt(0)
  s_branch L_loop
L_touch5:
  s_branch L_storage
L_vbody:
  ds_read_b64_tr_b16 v[84:85], v220 offset:0
  ds_read_b64_tr_b16 v[86:87], v220 offset:4096
  ds_read_b64_tr_b16 v[88:89], v221 offset:0
  v_pk_mul_f32 v[20:21], v[20:21], v[212:213] op_sel_hi:[1,0]
  v_pk_mul_f32 v[22:23], v[22:23], v[212:213] op_sel_hi:[1,0]
  ds_read_b64_tr_b16 v[90:91], v221 offset:4096
  v_pk_mul_f32 v[24:25], v[24:25], v[212:213] op_sel_hi:[1,0]
  v_pk_mul_f32 v[26:27], v[26:27], v[212:213] op_sel_hi:[1,0]
  ds_read_b64_tr_b16 v[92:93], v222 offset:0
  v_pk_mul_f32 v[28:29], v[28:29], v[212:213] op_sel_hi:[1,0]
  v_pk_mul_f32 v[30:31], v[30:31], v[212:213] op_sel_hi:[1,0]
  ds_read_b64_tr_b16 v[94:95], v222 offset:4096
  v_pk_mul_f32 v[32:33], v[32:33], v[212:213] op_sel_hi:[1,0]
  v_pk_mul_f32 v[34:35], v[34:35], v[212:213] op_sel_hi:[1,0]
  ds_read_b64_tr_b16 v[96:97], v223 offset:0
  v_pk_mul_f32 v[36:37], v[36:37], v[212:213] op_sel_hi:[1,0]
  v_pk_mul_f32 v[38:39], v[38:39], v[212:213] op_sel_hi:[1,0]
  ds_read_b64_tr_b16 v[98:99], v223 offset:4096
  v_pk_mul_f32 v[40:41], v[40:41], v[212:213] op_sel_hi:[1,0]
  v_pk_mul_f32 v[42:43], v[42:43], v[212:213] op_sel_hi:[1,0]
  ds_read_b64_tr_b16 v[100:101], v224 offset:0
  v_pk_mul_f32 v[44:45], v[44:45], v[212:213] op_sel_hi:[1,0]
  v_pk_mul_f32 v[46:47], v[46:47], v[212:213] op_sel_hi:[1,0]
  ds_read_b64_tr_b16 v[102:103], v224 offset:4096
  v_pk_mul_f32 v[48:49], v[48:49], v[212:213] op_sel_hi:[1,0]
  v_pk_mul_f32 v[50:51], v[50:51], v[212:213] op_sel_hi:[1,0]
  ds_read_b64_tr_b16 v[104:105], v225 offset:0
  s_add_u32 s25, s25, 1
  s_cmp_eq_u32 s25, 3
  ds_read_b64_tr_b16 v[106:107], v225 offset:4096
  s_cselect_b32 s25, 0, s25
  s_mov_b32 s24, 32768
  s_cmov_b32 s24, -65536
  s_waitcnt lgkmcnt(8)
  v_mfma_f32_16x16x32_bf16 v[20:23], v[84:87], v[148:151], v[20:23]
  ds_read_b64_tr_b16 v[108:109], v226 offset:0
  ds_read_b64_tr_b16 v[110:111], v226 offset:4096
  v_mfma_f32_16x16x32_bf16 v[24:27], v[88:91], v[148:151], v[24:27]
  ds_read_b64_tr_b16 v[112:113], v227 offset:0
  ds_read_b64_tr_b16 v[114:115], v227 offset:4096
  s_waitcnt lgkmcnt(8)
  v_mfma_f32_16x16x32_bf16 v[28:31], v[92:95], v[148:151], v[28:31]
  ds_read_b64_tr_b16 v[116:117], v220 offset:8192
  ds_read_b64_tr_b16 v[118:119], v220 offset:12288
  v_mfma_f32_16x16x32_bf16 v[32:35], v[96:99], v[148:151], v[32:35]
  ds_read_b64_tr_b16 v[120:121], v221 offset:8192
  ds_read_b64_tr_b16 v[122:123], v221 offset:12288
  s_waitcnt lgkmcnt(8)
  v_mfma_f32_16x16x32_bf16 v[36:39], v[100:103], v[148:151], v[36:39]
  ds_read_b64_tr_b16 v[124:125], v222 offset:8192
  ds_read_b64_tr_b16 v[126:127], v222 offset:12288
  v_mfma_f32_16x16x32_bf16 v[40:43], v[104:107], v[148:151], v[40:43]
  ds_read_b64_tr_b16 v[128:129], v223 offset:8192
  ds_read_b64_tr_b16 v[130:131], v223 offset:12288
  s_waitcnt lgkmcnt(8)
  v_mfma_f32_16x16x32_bf16 v[44:47], v[108:111], v[148:151], v[44:47]
  ds_read_b64_tr_b16 v[132:133], v224 offset:8192
  ds_read_b64_tr_b16 v[134:135], v224 offset:12288
  v_mfma_f32_16x16x32_bf16 v[48:51], v[112:115], v[148:151], v[48:51]
  ds_read_b64_tr_b16 v[136:137], v225 offset:8192
  ds_read_b64_tr_b16 v[138:139], v225 offset:12288
  s_waitcnt lgkmcnt(8)
  v_mfma_f32_16x16x32_bf16 v[20:23], v[116:119], v[152:155], v[20:23]
  ds_read_b64_tr_b16 v[140:141], v226 offset:8192
  ds_read_b64_tr_b16 v[142:143], v226 offset:12288
  v_mfma_f32_16x16x32_bf16 v[24:27], v[120:123], v[152:155], v[24:27]
  ds_read_b64_tr_b16 v[144:145], v227 offset:8192
  ds_read_b64_tr_b16 v[146:147], v227 offset:12288
  s_waitcnt lgkmcnt(8)
  v_mfma_f32_16x16x32_bf16 v[28:31], v[124:127], v[152:155], v[28:31]
  ds_read_b64_tr_b16 v[84:85], v220 offset:16384
  ds_read_b64_tr_b16 v[86:87], v220 offset:20480
  v_mfma_f32_16x16x32_bf16 v[32:35], v[128:131], v[152:155], v[32:35]
  ds_read_b64_tr_b16 v[88:89], v221 offset:16384
  ds_read_b64_tr_b16 v[90:91], v221 offset:20480
  s_waitcnt lgkmcnt(8)
  v_mfma_f32_16x16x32_bf16 v[36:39], v[132:135], v[152:155], v[36:39]
  ds_read_b64_tr_b16 v[92:93], v222 offset:16384
  ds_read_b64_tr_b16 v[94:95], v222 offset:20480
  v_mfma_f32_16x16x32_bf16 v[40:43], v[136:139], v[152:155], v[40:43]
  ds_read_b64_tr_b16 v[96:97], v223 offset:16384
  ds_read_b64_tr_b16 v[98:99], v223 offset:20480
  s_waitcnt lgkmcnt(8)
  v_mfma_f32_16x16x32_bf16 v[44:47], v[140:143], v[152:155], v[44:47]
  ds_read_b64_tr_b16 v[100:101], v224 offset:16384
  ds_read_b64_tr_b16 v[102:103], v224 offset:20480
  v_mfma_f32_16x16x32_bf16 v[48:51], v[144:147], v[152:155], v[48:51]
  ds_read_b64_tr_b16 v[104:105], v225 offset:16384
  ds_read_b64_tr_b16 v[106:107], v225 offset:20480
  s_waitcnt lgkmcnt(8)
  v_mfma_f32_16x16x32_bf16 v[20:23], v[84:87], v[156:159], v[20:23]
  ds_read_b64_tr_b16 v[108:109], v226 offset:16384
  ds_read_b64_tr_b16 v[110:111], v226 offset:20480
  v_mfma_f32_16x16x32_bf16 v[24:27], v[88:91], v[156:159], v[24:27]
  ds_read_b64_tr_b16 v[112:113], v227 offset:16384
  ds_read_b64_tr_b16 v[114:115], v227 offset:20480
  s_waitcnt lgkmcnt(8)
  v_mfma_f32_16x16x32_bf16 v[28:31], v[92:95], v[156:159], v[28:31]
  ds_read_b64_tr_b16 v[116:117], v220 offset:24576
  ds_read_b64_tr_b16 v[118:119], v220 offset:28672
  v_mfma_f32_16x16x32_bf16 v[32:35], v[96:99], v[156:159], v[32:35]
  ds_read_b64_tr_b16 v[120:121], v221 offset:24576
  ds_read_b64_tr_b16 v[122:123], v221 offset:28672
  s_waitcnt lgkmcnt(8)
  v_mfma_f32_16x16x32_bf16 v[36:39], v[100:103], v[156:159], v[36:39]
  ds_read_b64_tr_b16 v[124:125], v222 offset:24576
  ds_read_b64_tr_b16 v[126:127], v222 offset:28672
  v_mfma_f32_16x16x32_bf16 v[40:43], v[104:107], v[156:159], v[40:43]
  ds_read_b64_tr_b16 v[128:129], v223 offset:24576
  ds_read_b64_tr_b16 v[130:131], v223 offset:28672
  s_waitcnt lgkmcnt(8)
  v_mfma_f32_16x16x32_bf16 v[44:47], v[108:111], v[156:159], v[44:47]
  ds_read_b64_tr_b16 v[132:133], v224 offset:24576
  ds_read_b64_tr_b16 v[134:135], v224 offset:28672
  v_mfma_f32_16x16x32_bf16 v[48:51], v[112:115], v[156:159], v[48:51]
  ds_read_b64_tr_b16 v[136:137], v225 offset:24576
  ds_read_b64_tr_b16 v[138:139], v225 offset:28672
  s_waitcnt lgkmcnt(8)
  v_mfma_f32_16x16x32_bf16 v[20:23], v[116:119], v[160:163], v[20:23]
  ds_read_b64_tr_b16 v[140:141], v226 offset:24576
  ds_read_b64_tr_b16 v[142:143], v226 offset:28672
  v_mfma_f32_16x16x32_bf16 v[24:27], v[120:123], v[160:163], v[24:27]
  ds_read_b64_tr_b16 v[144:145], v227 offset:24576
  ds_read_b64_tr_b16 v[146:147], v227 offset:28672
  s_waitcnt lgkmcnt(8)
  v_mfma_f32_16x16x32_bf16 v[28:31], v[124:127], v[160:163], v[28:31]
  v_mfma_f32_16x16x32_bf16 v[32:35], v[128:131], v[160:163], v[32:35]
  s_waitcnt lgkmcnt(4)
  v_mfma_f32_16x16x32_bf16 v[36:39], v[132:135], v[160:163], v[36:39]
  v_mfma_f32_16x16x32_bf16 v[40:43], v[136:139], v[160:163], v[40:43]
  s_waitcnt lgkmcnt(0)
  v_mfma_f32_16x16x32_bf16 v[44:47], v[140:143], v[160:163], v[44:47]
  v_mfma_f32_16x16x32_bf16 v[48:51], v[144:147], v[160:163], v[48:51]
  v_add_u32 v216, s24, v216
  v_add_u32 v217, s24, v217
  v_add_u32 v218, s24, v218
  v_add_u32 v219, s24, v219
  v_add_u32 v220, s24, v220
  v_add_u32 v221, s24, v221
  v_add_u32 v222, s24, v222
  v_add_u32 v223, s24, v223
  v_add_u32 v224, s24, v224
  v_add_u32 v225, s24, v225
  v_add_u32 v226, s24, v226
  v_add_u32 v227, s24, v227
  ds_read_b32 v212, v213 offset:64
  ds_read_b32 v214, v213 offset:128
  v_add_u32 v213, 64, v213
  v_mov_b64 v[148:149], v[164:165]
  v_mov_b64 v[150:151], v[166:167]
  v_mov_b64 v[152:153], v[168:169]
  v_mov_b64 v[154:155], v[170:171]
  v_mov_b64 v[156:157], v[172:173]
  v_mov_b64 v[158:159], v[174:175]
  v_mov_b64 v[160:161], v[176:177]
  v_mov_b64 v[162:163], v[178:179]
  v_mov_b64 v[164:165], v[180:181]
  v_mov_b64 v[166:167], v[182:183]
  v_mov_b64 v[168:169], v[184:185]
  v_mov_b64 v[170:171], v[186:187]
  v_mov_b64 v[172:173], v[188:189]
  v_mov_b64 v[174:175], v[190:191]
  v_mov_b64 v[176:177], v[192:193]
  v_mov_b64 v[178:179], v[194:195]
  v_mov_b64 v[180:181], v[196:197]
  v_mov_b64 v[182:183], v[198:199]
  v_mov_b64 v[184:185], v[200:201]
  v_mov_b64 v[186:187], v[202:203]
  v_mov_b64 v[188:189], v[204:205]
  v_mov_b64 v[190:191], v[206:207]
  v_mov_b64 v[192:193], v[208:209]
  v_mov_b64 v[194:195], v[210:211]
  s_add_u32 s21, s21, 1
  s_cmp_ge_u32 s21, 28
  s_cbranch_scc1 L_refill2
  s_and_b32 s42, s21, 1
  s_xor_b32 s42, s42, 1
  s_cmp_eq_u32 s21, 27
  s_cmov_b32 s42, 2
  s_lshl_b32 s42, s42, 14
  v_add_u32 v230, s42, v239
  ds_read_b128 v[196:199], v230 offset:0
  ds_read_b128 v[200:203], v230 offset:1024
  ds_read_b128 v[204:207], v230 offset:2048
  ds_read_b128 v[208:211], v230 offset:3072
  s_waitcnt lgkmcnt(0)
  s_branch L_loop
.p2align 12
L_touch6:
  s_branch L_storage
L_refill2:
  v_mov_b64 v[196:197], v[52:53]
  v_mov_b64 v[198:199], v[54:55]
  v_mov_b64 v[200:201], v[56:57]
  v_mov_b64 v[202:203], v[58:59]
  v_mov_b64 v[204:205], v[60:61]
  v_mov_b64 v[206:207], v[62:63]
  v_mov_b64 v[208:209], v[64:65]
  v_mov_b64 v[210:211], v[66:67]
  s_waitcnt lgkmcnt(0)
  s_cmp_lt_u32 s21, 30
  s_cbranch_scc1 L_loop
  v_bfe_u32 v234, v242, 3, 2
  v_lshlrev_b32 v234, 1, v234
  v_lshrrev_b32 v233, 2, v242
  v_lshlrev_b32 v233, 7, v233
  v_and_b32 v235, 3, v242
  v_lshl_add_u32 v233, v235, 3, v233
  v_xor_b32 v235, 0, v234
  v_lshl_add_u32 v216, v235, 4, v233
  v_xor_b32 v235, 2, v234
  v_lshl_add_u32 v217, v235, 4, v233
  v_xor_b32 v235, 4, v234
  v_lshl_add_u32 v218, v235, 4, v233
  v_xor_b32 v235, 6, v234
  v_lshl_add_u32 v219, v235, 4, v233
  v_pk_mul_f32 v[20:21], v[20:21], v[212:213] op_sel_hi:[1,0]
  v_pk_mul_f32 v[22:23], v[22:23], v[212:213] op_sel_hi:[1,0]
  v_pk_mul_f32 v[24:25], v[24:25], v[212:213] op_sel_hi:[1,0]
  v_pk_mul_f32 v[26:27], v[26:27], v[212:213] op_sel_hi:[1,0]
  v_pk_mul_f32 v[28:29], v[28:29], v[212:213] op_sel_hi:[1,0]
  v_pk_mul_f32 v[30:31], v[30:31], v[212:213] op_sel_hi:[1,0]
  v_pk_mul_f32 v[32:33], v[32:33], v[212:213] op_sel_hi:[1,0]
  v_pk_mul_f32 v[34:35], v[34:35], v[212:213] op_sel_hi:[1,0]
  v_pk_mul_f32 v[36:37], v[36:37], v[212:213] op_sel_hi:[1,0]
  v_pk_mul_f32 v[38:39], v[38:39], v[212:213] op_sel_hi:[1,0]
  v_pk_mul_f32 v[40:41], v[40:41], v[212:213] op_sel_hi:[1,0]
  v_pk_mul_f32 v[42:43], v[42:43], v[212:213] op_sel_hi:[1,0]
  v_pk_mul_f32 v[44:45], v[44:45], v[212:213] op_sel_hi:[1,0]
  v_pk_mul_f32 v[46:47], v[46:47], v[212:213] op_sel_hi:[1,0]
  v_pk_mul_f32 v[48:49], v[48:49], v[212:213] op_sel_hi:[1,0]
  v_pk_mul_f32 v[50:51], v[50:51], v[212:213] op_sel_hi:[1,0]
  v_lshrrev_b32 v233, 3, v242
  v_and_b32 v234, 7, v242
  v_xor_b32 v235, v233, v234
  v_lshl_add_u32 v255, v233, 7, s74
  v_lshl_add_u32 v255, v235, 4, v255
  v_lshrrev_b32 v233, 5, v242
  v_xor_b32 v233, v233, v234
  v_lshl_add_u32 v220, v240, 4, s74
  v_lshl_add_u32 v220, v233, 4, v220
  v_bfe_u32 v233, v242, 4, 1
  v_lshl_add_u32 v220, v233, 3, v220
  v_xor_b32 v221, 32, v220
  v_xor_b32 v222, 64, v220
  v_xor_b32 v223, 96, v220
  s_mov_b32 s21, 262144
  v_cmp_ne_u32 vcc, v249, v241
  s_cbranch_vccz L_notready
L_ready:
  v_max_f32 v9, v228, v4
  v_sub_f32 v6, v228, v9
  v_sub_f32 v8, v4, v9
  v_exp_f32 v6, v6
  v_exp_f32 v8, v8
  v_mul_f32 v7, v229, v6
  v_mul_f32 v9, v5, v8
  v_add_f32 v7, v7, v9
  v_rcp_f32 v7, v7
  s_nop 0
  v_mul_f32 v6, v6, v7
  v_mul_f32 v8, v8, v7
  s_cmp_lg_u32 s68, 0
  s_barrier
  ds_read_b64_tr_b16 v[84:85], v216 offset:0
  ds_read_b64_tr_b16 v[86:87], v216 offset:2048
  ds_read_b64_tr_b16 v[88:89], v217 offset:0
  ds_read_b64_tr_b16 v[90:91], v217 offset:2048
  ds_read_b64_tr_b16 v[92:93], v218 offset:0
  ds_read_b64_tr_b16 v[94:95], v218 offset:2048
  ds_read_b64_tr_b16 v[96:97], v219 offset:0
  ds_read_b64_tr_b16 v[98:99], v219 offset:2048
  ds_read_b64_tr_b16 v[100:101], v216 offset:4096
  ds_read_b64_tr_b16 v[102:103], v216 offset:6144
  ds_read_b64_tr_b16 v[104:105], v217 offset:4096
  ds_read_b64_tr_b16 v[106:107], v217 offset:6144
  s_waitcnt lgkmcnt(10)
  v_mfma_f32_16x16x32_bf16 v[20:23], v[84:87], v[148:151], v[20:23]
  ds_read_b64_tr_b16 v[108:109], v218 offset:4096
  ds_read_b64_tr_b16 v[110:111], v218 offset:6144
  s_waitcnt lgkmcnt(10)
  v_mfma_f32_16x16x32_bf16 v[24:27], v[88:91], v[148:151], v[24:27]
  ds_read_b64_tr_b16 v[112:113], v219 offset:4096
  ds_read_b64_tr_b16 v[114:115], v219 offset:6144
  s_waitcnt lgkmcnt(10)
  v_mfma_f32_16x16x32_bf16 v[28:31], v[92:95], v[148:151], v[28:31]
  ds_read_b64_tr_b16 v[116:117], v216 offset:8192
  ds_read_b64_tr_b16 v[118:119], v216 offset:10240
  s_waitcnt lgkmcnt(10)
  v_mfma_f32_16x16x32_bf16 v[32:35], v[96:99], v[148:151], v[32:35]
  ds_read_b64_tr_b16 v[120:121], v217 offset:8192
  ds_read_b64_tr_b16 v[122:123], v217 offset:10240
  s_waitcnt lgkmcnt(10)
  v_mfma_f32_16x16x32_bf16 v[20:23], v[100:103], v[152:155], v[20:23]
  ds_read_b64_tr_b16 v[124:125], v218 offset:8192
  ds_read_b64_tr_b16 v[126:127], v218 offset:10240
  s_waitcnt lgkmcnt(10)
  v_mfma_f32_16x16x32_bf16 v[24:27], v[104:107], v[152:155], v[24:27]
  ds_read_b64_tr_b16 v[128:129], v219 offset:8192
  ds_read_b64_tr_b16 v[130:131], v219 offset:10240
  s_waitcnt lgkmcnt(10)
  v_mfma_f32_16x16x32_bf16 v[28:31], v[108:111], v[152:155], v[28:31]
  ds_read_b64_tr_b16 v[132:133], v216 offset:12288
  ds_read_b64_tr_b16 v[134:135], v216 offset:14336
  s_waitcnt lgkmcnt(10)
  v_mfma_f32_16x16x32_bf16 v[32:35], v[112:115], v[152:155], v[32:35]
  ds_read_b64_tr_b16 v[136:137], v217 offset:12288
  ds_read_b64_tr_b16 v[138:139], v217 offset:14336
  s_waitcnt lgkmcnt(10)
  v_mfma_f32_16x16x32_bf16 v[20:23], v[116:119], v[156:159], v[20:23]
  ds_read_b64_tr_b16 v[140:141], v218 offset:12288
  ds_read_b64_tr_b16 v[142:143], v218 offset:14336
  s_waitcnt lgkmcnt(10)
  v_mfma_f32_16x16x32_bf16 v[24:27], v[120:123], v[156:159], v[24:27]
  ds_read_b64_tr_b16 v[144:145], v219 offset:12288
  ds_read_b64_tr_b16 v[146:147], v219 offset:14336
  s_waitcnt lgkmcnt(10)
  v_mfma_f32_16x16x32_bf16 v[28:31], v[124:127], v[156:159], v[28:31]
  s_waitcnt lgkmcnt(8)
  v_mfma_f32_16x16x32_bf16 v[32:35], v[128:131], v[156:159], v[32:35]
  s_waitcnt lgkmcnt(6)
  v_mfma_f32_16x16x32_bf16 v[20:23], v[132:135], v[160:163], v[20:23]
  s_waitcnt lgkmcnt(4)
  v_mfma_f32_16x16x32_bf16 v[24:27], v[136:139], v[160:163], v[24:27]
  s_waitcnt lgkmcnt(2)
  v_mfma_f32_16x16x32_bf16 v[28:31], v[140:143], v[160:163], v[28:31]
  s_waitcnt lgkmcnt(0)
  v_mfma_f32_16x16x32_bf16 v[32:35], v[144:147], v[160:163], v[32:35]
  s_nop 2
  v_pk_mul_f32 v[20:21], v[20:21], v[214:215] op_sel_hi:[1,0]
  v_pk_mul_f32 v[22:23], v[22:23], v[214:215] op_sel_hi:[1,0]
  v_pk_mul_f32 v[24:25], v[24:25], v[214:215] op_sel_hi:[1,0]
  v_pk_mul_f32 v[26:27], v[26:27], v[214:215] op_sel_hi:[1,0]
  v_pk_mul_f32 v[28:29], v[28:29], v[214:215] op_sel_hi:[1,0]
  v_pk_mul_f32 v[30:31], v[30:31], v[214:215] op_sel_hi:[1,0]
  v_pk_mul_f32 v[32:33], v[32:33], v[214:215] op_sel_hi:[1,0]
  v_pk_mul_f32 v[34:35], v[34:35], v[214:215] op_sel_hi:[1,0]
  s_barrier
  ds_read_b64_tr_b16 v[84:85], v216 offset:16384
  ds_read_b64_tr_b16 v[86:87], v216 offset:18432
  ds_read_b64_tr_b16 v[88:89], v217 offset:16384
  ds_read_b64_tr_b16 v[90:91], v217 offset:18432
  ds_read_b64_tr_b16 v[92:93], v218 offset:16384
  ds_read_b64_tr_b16 v[94:95], v218 offset:18432
  ds_read_b64_tr_b16 v[96:97], v219 offset:16384
  ds_read_b64_tr_b16 v[98:99], v219 offset:18432
  ds_read_b64_tr_b16 v[100:101], v216 offset:20480
  ds_read_b64_tr_b16 v[102:103], v216 offset:22528
  ds_read_b64_tr_b16 v[104:105], v217 offset:20480
  ds_read_b64_tr_b16 v[106:107], v217 offset:22528
  s_waitcnt lgkmcnt(10)
  v_mfma_f32_16x16x32_bf16 v[20:23], v[84:87], v[164:167], v[20:23]
  ds_read_b64_tr_b16 v[108:109], v218 offset:20480
  ds_read_b64_tr_b16 v[110:111], v218 offset:22528
  s_waitcnt lgkmcnt(10)
  v_mfma_f32_16x16x32_bf16 v[24:27], v[88:91], v[164:167], v[24:27]
  ds_read_b64_tr_b16 v[112:113], v219 offset:20480
  ds_read_b64_tr_b16 v[114:115], v219 offset:22528
  s_waitcnt lgkmcnt(10)
  v_mfma_f32_16x16x32_bf16 v[28:31], v[92:95], v[164:167], v[28:31]
  ds_read_b64_tr_b16 v[116:117], v216 offset:24576
  ds_read_b64_tr_b16 v[118:119], v216 offset:26624
  s_waitcnt lgkmcnt(10)
  v_mfma_f32_16x16x32_bf16 v[32:35], v[96:99], v[164:167], v[32:35]
  ds_read_b64_tr_b16 v[120:121], v217 offset:24576
  ds_read_b64_tr_b16 v[122:123], v217 offset:26624
  s_waitcnt lgkmcnt(10)
  v_mfma_f32_16x16x32_bf16 v[20:23], v[100:103], v[168:171], v[20:23]
  ds_read_b64_tr_b16 v[124:125], v218 offset:24576
  ds_read_b64_tr_b16 v[126:127], v218 offset:26624
  s_waitcnt lgkmcnt(10)
  v_mfma_f32_16x16x32_bf16 v[24:27], v[104:107], v[168:171], v[24:27]
  ds_read_b64_tr_b16 v[128:129], v219 offset:24576
  ds_read_b64_tr_b16 v[130:131], v219 offset:26624
  s_waitcnt lgkmcnt(10)
  v_mfma_f32_16x16x32_bf16 v[28:31], v[108:111], v[168:171], v[28:31]
  ds_read_b64_tr_b16 v[132:133], v216 offset:28672
  ds_read_b64_tr_b16 v[134:135], v216 offset:30720
  s_waitcnt lgkmcnt(10)
  v_mfma_f32_16x16x32_bf16 v[32:35], v[112:115], v[168:171], v[32:35]
  ds_read_b64_tr_b16 v[136:137], v217 offset:28672
  ds_read_b64_tr_b16 v[138:139], v217 offset:30720
  s_waitcnt lgkmcnt(10)
  v_mfma_f32_16x16x32_bf16 v[20:23], v[116:119], v[172:175], v[20:23]
  ds_read_b64_tr_b16 v[140:141], v218 offset:28672
  ds_read_b64_tr_b16 v[142:143], v218 offset:30720
  s_waitcnt lgkmcnt(10)
  v_mfma_f32_16x16x32_bf16 v[24:27], v[120:123], v[172:175], v[24:27]
  ds_read_b64_tr_b16 v[144:145], v219 offset:28672
  ds_read_b64_tr_b16 v[146:147], v219 offset:30720
  s_waitcnt lgkmcnt(10)
  v_mfma_f32_16x16x32_bf16 v[28:31], v[124:127], v[172:175], v[28:31]
  s_waitcnt lgkmcnt(8)
  v_mfma_f32_16x16x32_bf16 v[32:35], v[128:131], v[172:175], v[32:35]
  s_waitcnt lgkmcnt(6)
  v_mfma_f32_16x16x32_bf16 v[20:23], v[132:135], v[176:179], v[20:23]
  s_waitcnt lgkmcnt(4)
  v_mfma_f32_16x16x32_bf16 v[24:27], v[136:139], v[176:179], v[24:27]
  s_waitcnt lgkmcnt(2)
  v_mfma_f32_16x16x32_bf16 v[28:31], v[140:143], v[176:179], v[28:31]
  s_waitcnt lgkmcnt(0)
  v_mfma_f32_16x16x32_bf16 v[32:35], v[144:147], v[176:179], v[32:35]
  s_nop 1
  s_cbranch_scc1 L_nosend
  v_pk_mul_f32 v[20:21], v[20:21], v[6:7] op_sel_hi:[1,0]
  v_pk_mul_f32 v[22:23], v[22:23], v[6:7] op_sel_hi:[1,0]
  v_pk_mul_f32 v[24:25], v[24:25], v[6:7] op_sel_hi:[1,0]
  v_pk_mul_f32 v[26:27], v[26:27], v[6:7] op_sel_hi:[1,0]
  v_pk_mul_f32 v[28:29], v[28:29], v[6:7] op_sel_hi:[1,0]
  v_pk_mul_f32 v[30:31], v[30:31], v[6:7] op_sel_hi:[1,0]
  v_pk_mul_f32 v[32:33], v[32:33], v[6:7] op_sel_hi:[1,0]
  v_pk_mul_f32 v[34:35], v[34:35], v[6:7] op_sel_hi:[1,0]
  v_cvt_pk_bf16_f32 v12, v20, v21
  v_cvt_pk_bf16_f32 v13, v22, v23
  v_cvt_pk_bf16_f32 v14, v24, v25
  v_cvt_pk_bf16_f32 v15, v26, v27
  v_min_u32 v12, -2, v12
  v_min_u32 v13, -2, v13
  v_min_u32 v14, -2, v14
  v_min_u32 v15, -2, v15
  buffer_store_dwordx4 v[12:15], v252, s[12:15], s67 offen offset:0
  v_cvt_pk_bf16_f32 v16, v28, v29
  v_cvt_pk_bf16_f32 v17, v30, v31
  v_cvt_pk_bf16_f32 v18, v32, v33
  v_cvt_pk_bf16_f32 v19, v34, v35
  v_min_u32 v16, -2, v16
  v_min_u32 v17, -2, v17
  v_min_u32 v18, -2, v18
  v_min_u32 v19, -2, v19
  buffer_store_dwordx4 v[16:19], v252, s[12:15], s67 offen offset:2048
L_nosend:
  s_barrier
  ds_read_b64_tr_b16 v[84:85], v216 offset:32768
  ds_read_b64_tr_b16 v[86:87], v216 offset:34816
  ds_read_b64_tr_b16 v[88:89], v217 offset:32768
  ds_read_b64_tr_b16 v[90:91], v217 offset:34816
  ds_read_b64_tr_b16 v[92:93], v218 offset:32768
  ds_read_b64_tr_b16 v[94:95], v218 offset:34816
  ds_read_b64_tr_b16 v[96:97], v219 offset:32768
  ds_read_b64_tr_b16 v[98:99], v219 offset:34816
  ds_read_b64_tr_b16 v[100:101], v216 offset:36864
  ds_read_b64_tr_b16 v[102:103], v216 offset:38912
  ds_read_b64_tr_b16 v[104:105], v217 offset:36864
  ds_read_b64_tr_b16 v[106:107], v217 offset:38912
  s_waitcnt lgkmcnt(10)
  v_mfma_f32_16x16x32_bf16 v[36:39], v[84:87], v[148:151], v[36:39]
  ds_read_b64_tr_b16 v[108:109], v218 offset:36864
  ds_read_b64_tr_b16 v[110:111], v218 offset:38912
  s_waitcnt lgkmcnt(10)
  v_mfma_f32_16x16x32_bf16 v[40:43], v[88:91], v[148:151], v[40:43]
  ds_read_b64_tr_b16 v[112:113], v219 offset:36864
  ds_read_b64_tr_b16 v[114:115], v219 offset:38912
  s_waitcnt lgkmcnt(10)
  v_mfma_f32_16x16x32_bf16 v[44:47], v[92:95], v[148:151], v[44:47]
  ds_read_b64_tr_b16 v[116:117], v216 offset:40960
  ds_read_b64_tr_b16 v[118:119], v216 offset:43008
  s_waitcnt lgkmcnt(10)
  v_mfma_f32_16x16x32_bf16 v[48:51], v[96:99], v[148:151], v[48:51]
  ds_read_b64_tr_b16 v[120:121], v217 offset:40960
  ds_read_b64_tr_b16 v[122:123], v217 offset:43008
  s_waitcnt lgkmcnt(10)
  v_mfma_f32_16x16x32_bf16 v[36:39], v[100:103], v[152:155], v[36:39]
  ds_read_b64_tr_b16 v[124:125], v218 offset:40960
  ds_read_b64_tr_b16 v[126:127], v218 offset:43008
  s_waitcnt lgkmcnt(10)
  v_mfma_f32_16x16x32_bf16 v[40:43], v[104:107], v[152:155], v[40:43]
  ds_read_b64_tr_b16 v[128:129], v219 offset:40960
  ds_read_b64_tr_b16 v[130:131], v219 offset:43008
  s_waitcnt lgkmcnt(10)
  v_mfma_f32_16x16x32_bf16 v[44:47], v[108:111], v[152:155], v[44:47]
  ds_read_b64_tr_b16 v[132:133], v216 offset:45056
  ds_read_b64_tr_b16 v[134:135], v216 offset:47104
  s_waitcnt lgkmcnt(10)
  v_mfma_f32_16x16x32_bf16 v[48:51], v[112:115], v[152:155], v[48:51]
  ds_read_b64_tr_b16 v[136:137], v217 offset:45056
  ds_read_b64_tr_b16 v[138:139], v217 offset:47104
  s_waitcnt lgkmcnt(10)
  v_mfma_f32_16x16x32_bf16 v[36:39], v[116:119], v[156:159], v[36:39]
  ds_read_b64_tr_b16 v[140:141], v218 offset:45056
  ds_read_b64_tr_b16 v[142:143], v218 offset:47104
  s_waitcnt lgkmcnt(10)
  v_mfma_f32_16x16x32_bf16 v[40:43], v[120:123], v[156:159], v[40:43]
  ds_read_b64_tr_b16 v[144:145], v219 offset:45056
  ds_read_b64_tr_b16 v[146:147], v219 offset:47104
  s_waitcnt lgkmcnt(10)
  v_mfma_f32_16x16x32_bf16 v[44:47], v[124:127], v[156:159], v[44:47]
  s_waitcnt lgkmcnt(8)
  v_mfma_f32_16x16x32_bf16 v[48:51], v[128:131], v[156:159], v[48:51]
  s_waitcnt lgkmcnt(6)
  v_mfma_f32_16x16x32_bf16 v[36:39], v[132:135], v[160:163], v[36:39]
  s_waitcnt lgkmcnt(4)
  v_mfma_f32_16x16x32_bf16 v[40:43], v[136:139], v[160:163], v[40:43]
  s_waitcnt lgkmcnt(2)
  v_mfma_f32_16x16x32_bf16 v[44:47], v[140:143], v[160:163], v[44:47]
  s_waitcnt lgkmcnt(0)
  v_mfma_f32_16x16x32_bf16 v[48:51], v[144:147], v[160:163], v[48:51]
  s_nop 2
  v_pk_mul_f32 v[36:37], v[36:37], v[214:215] op_sel_hi:[1,0]
  v_pk_mul_f32 v[38:39], v[38:39], v[214:215] op_sel_hi:[1,0]
  v_pk_mul_f32 v[40:41], v[40:41], v[214:215] op_sel_hi:[1,0]
  v_pk_mul_f32 v[42:43], v[42:43], v[214:215] op_sel_hi:[1,0]
  v_pk_mul_f32 v[44:45], v[44:45], v[214:215] op_sel_hi:[1,0]
  v_pk_mul_f32 v[46:47], v[46:47], v[214:215] op_sel_hi:[1,0]
  v_pk_mul_f32 v[48:49], v[48:49], v[214:215] op_sel_hi:[1,0]
  v_pk_mul_f32 v[50:51], v[50:51], v[214:215] op_sel_hi:[1,0]
  s_barrier
  ds_read_b64_tr_b16 v[84:85], v216 offset:49152
  ds_read_b64_tr_b16 v[86:87], v216 offset:51200
  ds_read_b64_tr_b16 v[88:89], v217 offset:49152
  ds_read_b64_tr_b16 v[90:91], v217 offset:51200
  ds_read_b64_tr_b16 v[92:93], v218 offset:49152
  ds_read_b64_tr_b16 v[94:95], v218 offset:51200
  ds_read_b64_tr_b16 v[96:97], v219 offset:49152
  ds_read_b64_tr_b16 v[98:99], v219 offset:51200
  ds_read_b64_tr_b16 v[100:101], v216 offset:53248
  ds_read_b64_tr_b16 v[102:103], v216 offset:55296
  ds_read_b64_tr_b16 v[104:105], v217 offset:53248
  ds_read_b64_tr_b16 v[106:107], v217 offset:55296
  s_waitcnt lgkmcnt(10)
  v_mfma_f32_16x16x32_bf16 v[36:39], v[84:87], v[164:167], v[36:39]
  ds_read_b64_tr_b16 v[108:109], v218 offset:53248
  ds_read_b64_tr_b16 v[110:111], v218 offset:55296
  s_waitcnt lgkmcnt(10)
  v_mfma_f32_16x16x32_bf16 v[40:43], v[88:91], v[164:167], v[40:43]
  ds_read_b64_tr_b16 v[112:113], v219 offset:53248
  ds_read_b64_tr_b16 v[114:115], v219 offset:55296
  s_waitcnt lgkmcnt(10)
  v_mfma_f32_16x16x32_bf16 v[44:47], v[92:95], v[164:167], v[44:47]
  s_waitcnt lgkmcnt(8)
  v_mfma_f32_16x16x32_bf16 v[48:51], v[96:99], v[164:167], v[48:51]
  s_waitcnt lgkmcnt(6)
  v_mfma_f32_16x16x32_bf16 v[36:39], v[100:103], v[168:171], v[36:39]
  s_waitcnt lgkmcnt(4)
  v_mfma_f32_16x16x32_bf16 v[40:43], v[104:107], v[168:171], v[40:43]
  s_waitcnt lgkmcnt(2)
  v_mfma_f32_16x16x32_bf16 v[44:47], v[108:111], v[168:171], v[44:47]
  s_waitcnt lgkmcnt(0)
  v_mfma_f32_16x16x32_bf16 v[48:51], v[112:115], v[168:171], v[48:51]
  s_barrier
  ds_read_b64_tr_b16 v[116:117], v216 offset:57344
  ds_read_b64_tr_b16 v[118:119], v216 offset:59392
  ds_read_b64_tr_b16 v[120:121], v217 offset:57344
  ds_read_b64_tr_b16 v[122:123], v217 offset:59392
  ds_read_b64_tr_b16 v[124:125], v218 offset:57344
  ds_read_b64_tr_b16 v[126:127], v218 offset:59392
  ds_read_b64_tr_b16 v[128:129], v219 offset:57344
  ds_read_b64_tr_b16 v[130:131], v219 offset:59392
  s_waitcnt lgkmcnt(6)
  v_mfma_f32_16x16x32_bf16 v[36:39], v[116:119], v[172:175], v[36:39]
  s_waitcnt lgkmcnt(4)
  v_mfma_f32_16x16x32_bf16 v[40:43], v[120:123], v[172:175], v[40:43]
  s_waitcnt lgkmcnt(2)
  v_mfma_f32_16x16x32_bf16 v[44:47], v[124:127], v[172:175], v[44:47]
  s_waitcnt lgkmcnt(0)
  v_mfma_f32_16x16x32_bf16 v[48:51], v[128:131], v[172:175], v[48:51]
  buffer_load_dwordx4 v[52:55], v252, s[12:15], s66 offen sc1
  buffer_load_dwordx4 v[56:59], v252, s[12:15], s66 offen offset:2048 sc1
  s_cmp_lg_u32 s68, 0
  s_barrier
  ds_read_b64_tr_b16 v[84:85], v216 offset:61440
  ds_read_b64_tr_b16 v[86:87], v216 offset:63488
  ds_read_b64_tr_b16 v[88:89], v217 offset:61440
  ds_read_b64_tr_b16 v[90:91], v217 offset:63488
  ds_read_b64_tr_b16 v[92:93], v218 offset:61440
  ds_read_b64_tr_b16 v[94:95], v218 offset:63488
  ds_read_b64_tr_b16 v[96:97], v219 offset:61440
  ds_read_b64_tr_b16 v[98:99], v219 offset:63488
  s_waitcnt lgkmcnt(6)
  v_mfma_f32_16x16x32_bf16 v[36:39], v[84:87], v[176:179], v[36:39]
  s_waitcnt lgkmcnt(4)
  v_mfma_f32_16x16x32_bf16 v[40:43], v[88:91], v[176:179], v[40:43]
  s_waitcnt lgkmcnt(2)
  v_mfma_f32_16x16x32_bf16 v[44:47], v[92:95], v[176:179], v[44:47]
  s_waitcnt lgkmcnt(0)
  v_mfma_f32_16x16x32_bf16 v[48:51], v[96:99], v[176:179], v[48:51]
  s_cbranch_scc1 L_generic
L_check:
  s_waitcnt vmcnt(0)
  v_max3_u32 v232, v52, v53, v54
  v_max3_u32 v233, v55, v56, v57
  v_max3_u32 v232, v232, v58, v59
  v_max_u32 v232, v232, v233
  v_cmp_eq_u32 vcc, -1, v232
  s_cbranch_vccnz L_retry
  v_lshlrev_b32 v68, 16, v52
  v_and_b32 v69, 0xffff0000, v52
  v_lshlrev_b32 v70, 16, v53
  v_and_b32 v71, 0xffff0000, v53
  v_lshlrev_b32 v72, 16, v54
  v_and_b32 v73, 0xffff0000, v54
  v_lshlrev_b32 v74, 16, v55
  v_and_b32 v75, 0xffff0000, v55
  v_pk_fma_f32 v[68:69], v[36:37], v[6:7], v[68:69] op_sel_hi:[1,0,1]
  v_pk_fma_f32 v[70:71], v[38:39], v[6:7], v[70:71] op_sel_hi:[1,0,1]
  v_pk_fma_f32 v[72:73], v[40:41], v[6:7], v[72:73] op_sel_hi:[1,0,1]
  v_pk_fma_f32 v[74:75], v[42:43], v[6:7], v[74:75] op_sel_hi:[1,0,1]
  v_cvt_pk_bf16_f32 v76, v68, v69
  v_cvt_pk_bf16_f32 v77, v70, v71
  ds_write_b64 v220, v[76:77]
  v_cvt_pk_bf16_f32 v78, v72, v73
  v_cvt_pk_bf16_f32 v79, v74, v75
  ds_write_b64 v221, v[78:79]
  v_lshlrev_b32 v68, 16, v56
  v_and_b32 v69, 0xffff0000, v56
  v_lshlrev_b32 v70, 16, v57
  v_and_b32 v71, 0xffff0000, v57
  v_lshlrev_b32 v72, 16, v58
  v_and_b32 v73, 0xffff0000, v58
  v_lshlrev_b32 v74, 16, v59
  v_and_b32 v75, 0xffff0000, v59
  v_pk_fma_f32 v[68:69], v[44:45], v[6:7], v[68:69] op_sel_hi:[1,0,1]
  v_pk_fma_f32 v[70:71], v[46:47], v[6:7], v[70:71] op_sel_hi:[1,0,1]
  v_pk_fma_f32 v[72:73], v[48:49], v[6:7], v[72:73] op_sel_hi:[1,0,1]
  v_pk_fma_f32 v[74:75], v[50:51], v[6:7], v[74:75] op_sel_hi:[1,0,1]
  v_cvt_pk_bf16_f32 v80, v68, v69
  v_cvt_pk_bf16_f32 v81, v70, v71
  ds_write_b64 v222, v[80:81]
  v_cvt_pk_bf16_f32 v82, v72, v73
  v_cvt_pk_bf16_f32 v83, v74, v75
  ds_write_b64 v223, v[82:83]
  ds_read_b128 v[68:71], v255 offset:0
  ds_read_b128 v[72:75], v255 offset:1024
  s_waitcnt lgkmcnt(1)
  buffer_store_dwordx4 v[68:71], v252, s[12:15], s66 offen offset:0
  s_waitcnt lgkmcnt(0)
  buffer_store_dwordx4 v[72:75], v252, s[12:15], s66 offen offset:2048
L_done:
L_end:
  s_endpgm
L_retry:
  buffer_load_dwordx4 v[52:55], v252, s[12:15], s66 offen sc1
  buffer_load_dwordx4 v[56:59], v252, s[12:15], s66 offen offset:2048 sc1
  s_sub_u32 s21, s21, 1
  s_cbranch_scc0 L_check
  s_endpgm
L_notready:
  s_cmp_lg_u32 s68, 0
  s_cbranch_scc1 L_ready
  buffer_load_dword v241, v244, s[16:19], s83 offen offset:256 sc1
  buffer_load_dword v233, v244, s[60:63], s76 offen sc1
  s_sub_u32 s21, s21, 1
  s_cbranch_scc1 L_end
  s_waitcnt vmcnt(0)
  v_cmp_ne_u32 vcc, v249, v241
  s_cbranch_vccnz L_readylate
  v_bfe_u32 v233, v233, s70, 1
  v_cmp_ne_u32 vcc, 0, v233
  s_cbranch_vccz L_notready
  s_mov_b32 s68, 2
  s_branch L_ready
L_readylate:
  buffer_load_dwordx2 v[4:5], v240, s[16:19], s81 offen sc1
  s_waitcnt vmcnt(0)
  s_branch L_ready
L_generic:
  s_waitcnt vmcnt(0)
  s_lshl_b32 s42, s40, 2
  s_add_u32 s42, s42, s20
  s_lshl_b32 s43, s42, 13
  s_add_u32 s45, s43, 4096
  s_lshl_b32 s44, s42, 9
  s_add_u32 s44, s44, 4194304
  s_lshl_b32 s46, 2, s70
  v_lshlrev_b32 v238, 4, v242
  v_lshlrev_b32 v233, 3, v242
  s_cmp_eq_u32 s68, 1
  s_cbranch_scc0 L_second
  buffer_store_dwordx2 v[228:229], v233, s[16:19], s44 offen sc1
  buffer_store_dwordx4 v[20:23], v238, s[16:19], s43 offen offset:0 sc1
  buffer_store_dwordx4 v[24:27], v238, s[16:19], s43 offen offset:1024 sc1
  buffer_store_dwordx4 v[28:31], v238, s[16:19], s43 offen offset:2048 sc1
  buffer_store_dwordx4 v[32:35], v238, s[16:19], s43 offen offset:3072 sc1
  buffer_store_dwordx4 v[36:39], v238, s[16:19], s45 offen offset:0 sc1
  buffer_store_dwordx4 v[40:43], v238, s[16:19], s45 offen offset:1024 sc1
  buffer_store_dwordx4 v[44:47], v238, s[16:19], s45 offen offset:2048 sc1
  buffer_store_dwordx4 v[48:51], v238, s[16:19], s45 offen offset:3072 sc1
  s_waitcnt vmcnt(0)
  s_barrier
  s_cmp_eq_u32 s20, 0
  s_cbranch_scc0 L_done
  v_mov_b32 v230, s46
  s_mov_b64 exec, 1
  buffer_atomic_or v230, v244, s[60:63], s76 offen sc1
  s_mov_b64 exec, -1
  s_branch L_done
L_second:
  buffer_load_dword v230, v244, s[60:63], s76 offen sc1
  s_sub_u32 s21, s21, 1
  s_cbranch_scc1 L_end
  s_waitcnt vmcnt(0)
  v_and_b32 v230, s46, v230
  v_cmp_ne_u32 vcc, 0, v230
  s_cbranch_vccz L_second
  buffer_load_dwordx2 v[4:5], v233, s[16:19], s44 offen sc1
  buffer_load_dwordx4 v[84:87], v238, s[16:19], s43 offen offset:0 sc1
  buffer_load_dwordx4 v[88:91], v238, s[16:19], s43 offen offset:1024 sc1
  buffer_load_dwordx4 v[92:95], v238, s[16:19], s43 offen offset:2048 sc1
  buffer_load_dwordx4 v[96:99], v238, s[16:19], s43 offen offset:3072 sc1
  buffer_load_dwordx4 v[100:103], v238, s[16:19], s45 offen offset:0 sc1
  buffer_load_dwordx4 v[104:107], v238, s[16:19], s45 offen offset:1024 sc1
  buffer_load_dwordx4 v[108:111], v238, s[16:19], s45 offen offset:2048 sc1
  buffer_load_dwordx4 v[112:115], v238, s[16:19], s45 offen offset:3072 sc1
  s_waitcnt vmcnt(0)
  v_max_f32 v9, v228, v4
  v_sub_f32 v6, v228, v9
  v_sub_f32 v8, v4, v9
  v_exp_f32 v6, v6
  v_exp_f32 v8, v8
  v_mul_f32 v7, v229, v6
  v_mul_f32 v9, v5, v8
  v_add_f32 v7, v7, v9
  v_rcp_f32 v7, v7
  s_nop 0
  v_mul_f32 v6, v6, v7
  v_mul_f32 v8, v8, v7
  v_pk_mul_f32 v[84:85], v[84:85], v[8:9] op_sel_hi:[1,0]
  v_pk_mul_f32 v[86:87], v[86:87], v[8:9] op_sel_hi:[1,0]
  v_pk_mul_f32 v[88:89], v[88:89], v[8:9] op_sel_hi:[1,0]
  v_pk_mul_f32 v[90:91], v[90:91], v[8:9] op_sel_hi:[1,0]
  v_pk_mul_f32 v[92:93], v[92:93], v[8:9] op_sel_hi:[1,0]
  v_pk_mul_f32 v[94:95], v[94:95], v[8:9] op_sel_hi:[1,0]
  v_pk_mul_f32 v[96:97], v[96:97], v[8:9] op_sel_hi:[1,0]
  v_pk_mul_f32 v[98:99], v[98:99], v[8:9] op_sel_hi:[1,0]
  v_pk_mul_f32 v[20:21], v[20:21], v[6:7] op_sel_hi:[1,0]
  v_pk_mul_f32 v[22:23], v[22:23], v[6:7] op_sel_hi:[1,0]
  v_pk_mul_f32 v[24:25], v[24:25], v[6:7] op_sel_hi:[1,0]
  v_pk_mul_f32 v[26:27], v[26:27], v[6:7] op_sel_hi:[1,0]
  v_pk_mul_f32 v[28:29], v[28:29], v[6:7] op_sel_hi:[1,0]
  v_pk_mul_f32 v[30:31], v[30:31], v[6:7] op_sel_hi:[1,0]
  v_pk_mul_f32 v[32:33], v[32:33], v[6:7] op_sel_hi:[1,0]
  v_pk_mul_f32 v[34:35], v[34:35], v[6:7] op_sel_hi:[1,0]
  v_cvt_pk_bf16_f32 v52, v84, v85
  v_cvt_pk_bf16_f32 v60, v20, v21
  v_cvt_pk_bf16_f32 v53, v86, v87
  v_cvt_pk_bf16_f32 v61, v22, v23
  v_cvt_pk_bf16_f32 v54, v88, v89
  v_cvt_pk_bf16_f32 v62, v24, v25
  v_cvt_pk_bf16_f32 v55, v90, v91
  v_cvt_pk_bf16_f32 v63, v26, v27
  v_cvt_pk_bf16_f32 v56, v92, v93
  v_cvt_pk_bf16_f32 v64, v28, v29
  v_cvt_pk_bf16_f32 v57, v94, v95
  v_cvt_pk_bf16_f32 v65, v30, v31
  v_cvt_pk_bf16_f32 v58, v96, v97
  v_cvt_pk_bf16_f32 v66, v32, v33
  v_cvt_pk_bf16_f32 v59, v98, v99
  v_cvt_pk_bf16_f32 v67, v34, v35
  v_lshlrev_b32 v68, 16, v52
  v_and_b32 v69, 0xffff0000, v52
  v_lshlrev_b32 v70, 16, v53
  v_and_b32 v71, 0xffff0000, v53
  v_lshlrev_b32 v72, 16, v54
  v_and_b32 v73, 0xffff0000, v54
  v_lshlrev_b32 v74, 16, v55
  v_and_b32 v75, 0xffff0000, v55
  v_pk_fma_f32 v[68:69], v[36:37], v[6:7], v[68:69] op_sel_hi:[1,0,1]
  v_pk_fma_f32 v[70:71], v[38:39], v[6:7], v[70:71] op_sel_hi:[1,0,1]
  v_pk_fma_f32 v[72:73], v[40:41], v[6:7], v[72:73] op_sel_hi:[1,0,1]
  v_pk_fma_f32 v[74:75], v[42:43], v[6:7], v[74:75] op_sel_hi:[1,0,1]
  v_cvt_pk_bf16_f32 v76, v68, v69
  v_cvt_pk_bf16_f32 v77, v70, v71
  ds_write_b64 v220, v[76:77]
  v_cvt_pk_bf16_f32 v78, v72, v73
  v_cvt_pk_bf16_f32 v79, v74, v75
  ds_write_b64 v221, v[78:79]
  v_lshlrev_b32 v68, 16, v56
  v_and_b32 v69, 0xffff0000, v56
  v_lshlrev_b32 v70, 16, v57
  v_and_b32 v71, 0xffff0000, v57
  v_lshlrev_b32 v72, 16, v58
  v_and_b32 v73, 0xffff0000, v58
  v_lshlrev_b32 v74, 16, v59
  v_and_b32 v75, 0xffff0000, v59
  v_pk_fma_f32 v[68:69], v[44:45], v[6:7], v[68:69] op_sel_hi:[1,0,1]
  v_pk_fma_f32 v[70:71], v[46:47], v[6:7], v[70:71] op_sel_hi:[1,0,1]
  v_pk_fma_f32 v[72:73], v[48:49], v[6:7], v[72:73] op_sel_hi:[1,0,1]
  v_pk_fma_f32 v[74:75], v[50:51], v[6:7], v[74:75] op_sel_hi:[1,0,1]
  v_cvt_pk_bf16_f32 v80, v68, v69
  v_cvt_pk_bf16_f32 v81, v70, v71
  ds_write_b64 v222, v[80:81]
  v_cvt_pk_bf16_f32 v82, v72, v73
  v_cvt_pk_bf16_f32 v83, v74, v75
  ds_write_b64 v223, v[82:83]
  ds_read_b128 v[68:71], v255 offset:0
  ds_read_b128 v[72:75], v255 offset:1024
  s_waitcnt lgkmcnt(1)
  buffer_store_dwordx4 v[68:71], v252, s[12:15], s66 offen offset:0
  s_waitcnt lgkmcnt(0)
  buffer_store_dwordx4 v[72:75], v252, s[12:15], s66 offen offset:2048
  v_lshlrev_b32 v12, 16, v60
  v_and_b32 v13, 0xffff0000, v60
  v_lshlrev_b32 v14, 16, v61
  v_and_b32 v15, 0xffff0000, v61
  v_lshlrev_b32 v16, 16, v62
  v_and_b32 v17, 0xffff0000, v62
  v_lshlrev_b32 v18, 16, v63
  v_and_b32 v19, 0xffff0000, v63
  v_pk_fma_f32 v[12:13], v[100:101], v[8:9], v[12:13] op_sel_hi:[1,0,1]
  v_pk_fma_f32 v[14:15], v[102:103], v[8:9], v[14:15] op_sel_hi:[1,0,1]
  v_pk_fma_f32 v[16:17], v[104:105], v[8:9], v[16:17] op_sel_hi:[1,0,1]
  v_pk_fma_f32 v[18:19], v[106:107], v[8:9], v[18:19] op_sel_hi:[1,0,1]
  v_cvt_pk_bf16_f32 v76, v12, v13
  v_cvt_pk_bf16_f32 v77, v14, v15
  ds_write_b64 v220, v[76:77]
  v_cvt_pk_bf16_f32 v78, v16, v17
  v_cvt_pk_bf16_f32 v79, v18, v19
  ds_write_b64 v221, v[78:79]
  v_lshlrev_b32 v12, 16, v64
  v_and_b32 v13, 0xffff0000, v64
  v_lshlrev_b32 v14, 16, v65
  v_and_b32 v15, 0xffff0000, v65
  v_lshlrev_b32 v16, 16, v66
  v_and_b32 v17, 0xffff0000, v66
  v_lshlrev_b32 v18, 16, v67
  v_and_b32 v19, 0xffff0000, v67
  v_pk_fma_f32 v[12:13], v[108:109], v[8:9], v[12:13] op_sel_hi:[1,0,1]
  v_pk_fma_f32 v[14:15], v[110:111], v[8:9], v[14:15] op_sel_hi:[1,0,1]
  v_pk_fma_f32 v[16:17], v[112:113], v[8:9], v[16:17] op_sel_hi:[1,0,1]
  v_pk_fma_f32 v[18:19], v[114:115], v[8:9], v[18:19] op_sel_hi:[1,0,1]
  v_cvt_pk_bf16_f32 v80, v12, v13
  v_cvt_pk_bf16_f32 v81, v14, v15
  ds_write_b64 v222, v[80:81]
  v_cvt_pk_bf16_f32 v82, v16, v17
  v_cvt_pk_bf16_f32 v83, v18, v19
  ds_write_b64 v223, v[82:83]
  ds_read_b128 v[12:15], v255 offset:0
  ds_read_b128 v[16:19], v255 offset:1024
  s_waitcnt lgkmcnt(1)
  buffer_store_dwordx4 v[12:15], v252, s[12:15], s67 offen offset:0
  s_waitcnt lgkmcnt(0)
  buffer_store_dwordx4 v[16:19], v252, s[12:15], s67 offen offset:2048
  s_branch L_done
L_storage:
  v_and_b32 v1, 63, v0
  v_lshlrev_b32 v1, 4, v1
  s_and_b32 s42, s20, 1
  s_lshl_b32 s42, s42, 14
  s_sub_u32 s43, 131072, s42
  v_add_u32 v2, s43, v1
  s_add_u32 s43, s42, 114688
  v_add_u32 v3, s43, v1
  s_add_u32 s43, s42, 98304
  v_add_u32 v4, s43, v1
  s_sub_u32 s43, 114688, s42
  v_add_u32 v5, s43, v1
  s_add_u32 s21, s20, 1
L_st_k0:
  s_barrier
  s_sub_u32 s21, s21, 1
  s_cbranch_scc0 L_st_k0
  ds_read_b128 v[8:11], v2 offset:0
  ds_read_b128 v[12:15], v2 offset:1024
  ds_read_b128 v[16:19], v2 offset:2048
  ds_read_b128 v[20:23], v2 offset:3072
  ds_read_b128 v[24:27], v2 offset:4096
  ds_read_b128 v[28:31], v2 offset:5120
  ds_read_b128 v[32:35], v2 offset:6144
  ds_read_b128 v[36:39], v2 offset:7168
  ds_read_b128 v[40:43], v2 offset:8192
  ds_read_b128 v[44:47], v2 offset:9216
  ds_read_b128 v[48:51], v2 offset:10240
  ds_read_b128 v[52:55], v2 offset:11264
  ds_read_b128 v[56:59], v2 offset:12288
  ds_read_b128 v[60:63], v2 offset:13312
  ds_read_b128 v[64:67], v2 offset:14336
  s_waitcnt lgkmcnt(11)
  ds_read_b128 v[68:71], v2 offset:15360
  s_mov_b32 s21, 2
  s_waitcnt lgkmcnt(0)
L_st_k1:
  s_barrier
  s_sub_u32 s21, s21, 1
  s_cbranch_scc0 L_st_k1
  ds_read_b128 v[72:75], v3 offset:0
  ds_read_b128 v[76:79], v3 offset:1024
  ds_read_b128 v[80:83], v3 offset:2048
  ds_read_b128 v[84:87], v3 offset:3072
  ds_read_b128 v[88:91], v3 offset:4096
  ds_read_b128 v[92:95], v3 offset:5120
  ds_read_b128 v[96:99], v3 offset:6144
  ds_read_b128 v[100:103], v3 offset:7168
  ds_read_b128 v[104:107], v3 offset:8192
  ds_read_b128 v[108:111], v3 offset:9216
  ds_read_b128 v[112:115], v3 offset:10240
  ds_read_b128 v[116:119], v3 offset:11264
  ds_read_b128 v[120:123], v3 offset:12288
  ds_read_b128 v[124:127], v3 offset:13312
  ds_read_b128 v[128:131], v3 offset:14336
  s_waitcnt lgkmcnt(11)
  ds_read_b128 v[132:135], v3 offset:15360
  s_mov_b32 s21, 2
  s_waitcnt lgkmcnt(0)
L_st_k2:
  s_barrier
  s_sub_u32 s21, s21, 1
  s_cbranch_scc0 L_st_k2
  ds_read_b128 v[136:139], v2 offset:0
  ds_read_b128 v[140:143], v2 offset:1024
  ds_read_b128 v[144:147], v2 offset:2048
  ds_read_b128 v[148:151], v2 offset:3072
  ds_read_b128 v[152:155], v2 offset:4096
  ds_read_b128 v[156:159], v2 offset:5120
  ds_read_b128 v[160:163], v2 offset:6144
  ds_read_b128 v[164:167], v2 offset:7168
  ds_read_b128 v[168:171], v2 offset:8192
  ds_read_b128 v[172:175], v2 offset:9216
  ds_read_b128 v[176:179], v2 offset:10240
  ds_read_b128 v[180:183], v2 offset:11264
  ds_read_b128 v[184:187], v2 offset:12288
  ds_read_b128 v[188:191], v2 offset:13312
  ds_read_b128 v[192:195], v2 offset:14336
  s_waitcnt lgkmcnt(11)
  ds_read_b128 v[196:199], v2 offset:15360
  s_mov_b32 s21, 3
  s_waitcnt lgkmcnt(0)
L_st_v0:
  s_barrier
  s_sub_u32 s21, s21, 1
  s_cbranch_scc0 L_st_v0
  ds_write_b128 v4, v[8:11] offset:0
  ds_write_b128 v4, v[12:15] offset:1024
  ds_write_b128 v4, v[16:19] offset:2048
  ds_write_b128 v4, v[20:23] offset:3072
  ds_write_b128 v4, v[24:27] offset:4096
  ds_write_b128 v4, v[28:31] offset:5120
  ds_write_b128 v4, v[32:35] offset:6144
  ds_write_b128 v4, v[36:39] offset:7168
  ds_write_b128 v4, v[40:43] offset:8192
  ds_write_b128 v4, v[44:47] offset:9216
  ds_write_b128 v4, v[48:51] offset:10240
  ds_write_b128 v4, v[52:55] offset:11264
  ds_write_b128 v4, v[56:59] offset:12288
  ds_write_b128 v4, v[60:63] offset:13312
  ds_write_b128 v4, v[64:67] offset:14336
  s_waitcnt lgkmcnt(11)
  ds_write_b128 v4, v[68:71] offset:15360
  s_mov_b32 s21, 2
  s_waitcnt lgkmcnt(0)
L_st_v1:
  s_barrier
  s_sub_u32 s21, s21, 1
  s_cbranch_scc0 L_st_v1
  ds_write_b128 v5, v[72:75] offset:0
  ds_write_b128 v5, v[76:79] offset:1024
  ds_write_b128 v5, v[80:83] offset:2048
  ds_write_b128 v5, v[84:87] offset:3072
  ds_write_b128 v5, v[88:91] offset:4096
  ds_write_b128 v5, v[92:95] offset:5120
  ds_write_b128 v5, v[96:99] offset:6144
  ds_write_b128 v5, v[100:103] offset:7168
  ds_write_b128 v5, v[104:107] offset:8192
  ds_write_b128 v5, v[108:111] offset:9216
  ds_write_b128 v5, v[112:115] offset:10240
  ds_write_b128 v5, v[116:119] offset:11264
  ds_write_b128 v5, v[120:123] offset:12288
  ds_write_b128 v5, v[124:127] offset:13312
  ds_write_b128 v5, v[128:131] offset:14336
  s_waitcnt lgkmcnt(11)
  ds_write_b128 v5, v[132:135] offset:15360
  s_mov_b32 s21, 2
  s_waitcnt lgkmcnt(0)
L_st_v2:
  s_barrier
  s_sub_u32 s21, s21, 1
  s_cbranch_scc0 L_st_v2
  ds_write_b128 v4, v[136:139] offset:0
  ds_write_b128 v4, v[140:143] offset:1024
  ds_write_b128 v4, v[144:147] offset:2048
  ds_write_b128 v4, v[148:151] offset:3072
  ds_write_b128 v4, v[152:155] offset:4096
  ds_write_b128 v4, v[156:159] offset:5120
  ds_write_b128 v4, v[160:163] offset:6144
  ds_write_b128 v4, v[164:167] offset:7168
  ds_write_b128 v4, v[168:171] offset:8192
  ds_write_b128 v4, v[172:175] offset:9216
  ds_write_b128 v4, v[176:179] offset:10240
  ds_write_b128 v4, v[180:183] offset:11264
  ds_write_b128 v4, v[184:187] offset:12288
  ds_write_b128 v4, v[188:191] offset:13312
  ds_write_b128 v4, v[192:195] offset:14336
  s_waitcnt lgkmcnt(11)
  ds_write_b128 v4, v[196:199] offset:15360
  s_mov_b32 s21, 2
  s_waitcnt lgkmcnt(0)
  s_endpgm
.section .rodata,"a"
.p2align 6
.amdhsa_kernel standalone__gqa_softmax__sampling_kernel
  .amdhsa_next_free_vgpr 256
  .amdhsa_next_free_sgpr 96
  .amdhsa_accum_offset 256
  .amdhsa_group_segment_fixed_size 0
  .amdhsa_kernarg_size 48
  .amdhsa_user_sgpr_count 2
  .amdhsa_user_sgpr_kernarg_segment_ptr 1
  .amdhsa_system_sgpr_workgroup_id_x 1
.end_amdhsa_kernel
```
